```python
import torch

def _softmax(x, axis=-1):
    return torch.softmax(x, dim=axis)
def _gelu(x):
    return torch.nn.functional.gelu(x, approximate="tanh")
def _silu(x):
    return torch.nn.functional.silu(x)
def _sigmoid(x):
    return torch.sigmoid(x)
def _layernorm(x, axis=-1, eps=1e-5):
    m = x.mean(dim=axis, keepdim=True)
    v = x.var(dim=axis, keepdim=True, unbiased=False)
    return (x - m) / torch.sqrt(v + eps)
def _scatter_add(tgt, idx, src, axis=0):
    return tgt.clone().index_add_(axis, idx, src)
def _segment_sum(src, seg, n):
    out = torch.zeros((n,) + src.shape[1:], dtype=src.dtype)
    return out.index_add_(0, seg, src)
def _pad(x, pw):
    flat = tuple(v for pair in reversed(pw) for v in pair)
    return torch.nn.functional.pad(x, flat)

kernel_name = 'parallel_sum__gqa_block_cached__mixer_token_mlp__decode'

def setup_inputs():

    _w = (lambda a: (lambda t: t.to(torch.bfloat16) if t.is_floating_point() else t)(torch.as_tensor(a)))
    def _A_setup():
        B, Sq, D = 2, 1, 576
        Hq, Hkv, Sk, Dh = 32, 16, 32768, 128
        assert Hq % Hkv == 0, (Hq, Hkv)
        return {
            "x": _w((lambda *s: torch.randn(*s, dtype=torch.bfloat16) * 0.05)(B, Sq, D)),
            "k_cache": _w((lambda *s: torch.randn(*s, dtype=torch.bfloat16) * 3.2)(B, Hkv, Sk, Dh)),
            "v_cache": _w((lambda *s: torch.randn(*s, dtype=torch.bfloat16) * 0.8)(B, Hkv, Sk, Dh)),
            "wq": _w((lambda *s: torch.randn(*s, dtype=torch.bfloat16) * 3.2)(D, Hq * Dh) * (D ** -0.5)),
            "wo": _w((lambda *s: torch.randn(*s, dtype=torch.bfloat16) * 0.8)(Hq * Dh, D) * ((Hq * Dh) ** -0.5)),
        }
    _A_in = _A_setup()

    def _B_setup():
        B, S, D, F = 2, 1, 576, 4608
        return {
            "x": _w((lambda *s: torch.randn(*s, dtype=torch.bfloat16) * 0.05)(B, S, D)),
            "w1": _w((lambda *s: torch.randn(*s, dtype=torch.bfloat16) * 3.2)(S, F) * (S ** -0.5)),
            "b1": _w((lambda *s: torch.randn(*s, dtype=torch.bfloat16) * 3.2)(F) * 0.02),
            "w2": _w((lambda *s: torch.randn(*s, dtype=torch.bfloat16) * 0.8)(F, S) * (F ** -0.5)),
            "b2": _w((lambda *s: torch.randn(*s, dtype=torch.bfloat16) * 0.8)(S) * 0.02),
        }
    _B_in = _B_setup()

    return {
        "A_x": _A_in["x"],
        "A_k_cache": _A_in["k_cache"],
        "A_v_cache": _A_in["v_cache"],
        "A_wq": _A_in["wq"],
        "A_wo": _A_in["wo"],
        "B_x": _B_in["x"],
        "B_w1": _B_in["w1"],
        "B_b1": _B_in["b1"],
        "B_w2": _B_in["w2"],
        "B_b2": _B_in["b2"],
    }

def reference(A_x, A_k_cache, A_v_cache, A_wq, A_wo, B_x, B_w1, B_b1, B_w2, B_b2):
    def _A_ref(x, k_cache, v_cache, wq, wo):
        B, Sq, D = x.shape
        Hq, Dh = 32, 128
        Hkv = k_cache.shape[1]
        rep = Hq // Hkv
        q = (lambda x, *d: x.permute(*d))((x @ wq).reshape(B, Sq, Hq, Dh), 0, 2, 1, 3)
        k = (lambda x, n, axis: torch.repeat_interleave(x, n, dim=axis))(k_cache, rep, axis=1)
        v = (lambda x, n, axis: torch.repeat_interleave(x, n, dim=axis))(v_cache, rep, axis=1)
        scores = torch.einsum("bhqd,bhkd->bhqk", q, k) * (Dh ** -0.5)
        p = _softmax(scores, axis=-1)
        o = torch.einsum("bhqk,bhkd->bhqd", p, v)
        return (lambda x, *d: x.permute(*d))(o, 0, 2, 1, 3).reshape(B, Sq, Hq * Dh) @ wo

    def _B_ref(x, w1, b1, w2, b2):
        B, S, D = x.shape
        h = _layernorm(x, axis=-1)
        u = torch.einsum("bsd,sf->bdf", h, w1) + b1
        u = _gelu(u)
        y = torch.einsum("bdf,fs->bds", u, w2) + b2
        return (lambda x, *d: x.permute(*d))(y, 0, 2, 1)

    x = A_x
    xn = _layernorm(x, axis=-1)
    return x + _A_ref(xn, A_k_cache, A_v_cache, A_wq, A_wo) + _B_ref(xn, B_w1, B_b1, B_w2, B_b2)
```

```asm
; @launch grid=(256,1,1) block=(512,1,1) lds=66048
.amdgcn_target "amdgcn-amd-amdhsa--gfx950"
.text
.globl parallel_sum__gqa_block_cached__mixer_token_mlp__decode_kernel
.p2align 8
.type parallel_sum__gqa_block_cached__mixer_token_mlp__decode_kernel,@function
parallel_sum__gqa_block_cached__mixer_token_mlp__decode_kernel:
  s_cmp_ge_u32 s2, 256
  s_cbranch_scc1 L_end
  s_load_dwordx16 s[4:19], s[0:1], 0
  s_load_dwordx8 s[20:27], s[0:1], 64
  s_load_dwordx2 s[28:29], s[0:1], 96
  v_lshrrev_b32 v1, 6, v0
  v_and_b32 v0, 63, v0
  v_readfirstlane_b32 s3, v1
  s_bfe_u32 s30, s2, 0x40003
  s_lshr_b32 s31, s2, 7
  s_and_b32 s32, s2, 7
  s_and_b32 s77, s2, 127
  s_bfe_u32 s34, s2, 65539
  s_lshl_b32 s33, s34, 14
  s_bfe_u32 s34, s2, 65540
  s_lshl_b32 s34, s34, 21
  s_xor_b32 s33, s33, s34
  s_bfe_u32 s34, s2, 65541
  s_lshl_b32 s34, s34, 20
  s_xor_b32 s33, s33, s34
  s_bfe_u32 s34, s2, 65542
  s_lshl_b32 s34, s34, 22
  s_xor_b32 s33, s33, s34
  s_bfe_u32 s34, s2, 65543
  s_lshl_b32 s34, s34, 13
  s_xor_b32 s33, s33, s34
  v_and_b32 v24, 15, v0
  v_lshrrev_b32 v25, 4, v0
  v_lshlrev_b32 v27, 4, v24
  v_mov_b32 v252, 512
  s_cmp_eq_u32 s3, 0
  s_cbranch_scc1 L_helper
  v_bfe_u32 v26, v0, 2, 2
  v_lshlrev_b32 v26, 8, v26
  v_lshl_add_u32 v26, v25, 6, v26
  v_and_b32 v28, 3, v0
  v_lshl_add_u32 v1, v28, 4, v26
  v_lshlrev_b32 v2, 4, v0
  s_lshr_b32 s34, s2, 3
  s_lshl_b32 s34, s34, 23
  s_mov_b32 s38, 0x800000
  s_mov_b32 s42, 0x800000
  s_mov_b32 s39, 0x20000
  s_mov_b32 s43, 0x20000
  s_lshl_b32 s80, s32, 20
  s_xor_b32 s80, s80, s33
  s_sub_u32 s82, s3, 1
  s_lshl_b32 s82, s82, 12
  s_and_b32 s35, s82, 4294934528
  s_add_u32 s64, s82, s35
  s_xor_b32 s64, s64, s80
  s_add_u32 s82, s82, 28672
  s_and_b32 s35, s82, 4294934528
  s_add_u32 s65, s82, s35
  s_xor_b32 s65, s65, s80
  s_waitcnt lgkmcnt(0)
  s_add_u32 s36, s6, s34
  s_addc_u32 s37, s7, 0
  s_and_b32 s37, s37, 0xffff
  s_cmp_gt_u32 s3, 3
  s_cbranch_scc0 L_ek
  s_barrier
L_ek:
  buffer_load_dwordx4 v[64:67], v1, s[36:39], s64 offen offset:0 nt
  buffer_load_dwordx4 v[68:71], v1, s[36:39], s64 offen offset:1024 nt
  buffer_load_dwordx4 v[72:75], v1, s[36:39], s64 offen offset:2048 nt
  buffer_load_dwordx4 v[76:79], v1, s[36:39], s64 offen offset:3072 nt
  s_cmp_gt_u32 s3, 3
  s_cbranch_scc1 L_ek2
  s_barrier
L_ek2:
  s_add_u32 s40, s8, s34
  s_addc_u32 s41, s9, 0
  s_and_b32 s41, s41, 0xffff
  s_mov_b32 s56, s28
  s_and_b32 s57, s29, 0xffff
  s_mov_b32 s58, 4194560
  s_mov_b32 s59, 0x20000
  s_mov_b32 s52, s12
  s_and_b32 s53, s13, 0xffff
  s_mov_b32 s54, 4718592
  s_mov_b32 s55, 0x20000
  s_mov_b32 s71, 0x3fb8aa3b
  s_mov_b32 s72, 0xbfb8aa3b
  v_lshlrev_b32 v253, 4, v0
  s_mov_b32 s70, 0x3db504f3
  s_mov_b32 s74, 0x00ff00ff
  s_mov_b32 s75, 0xff00ff00
  v_and_b32 v26, 1, v0
  v_cmp_eq_u32 vcc, 1, v26
  v_mov_b32 v26, 0x0c0c0100
  v_mov_b32 v27, 0x01000c0c
  v_cndmask_b32 v26, v26, v27, vcc
  v_mov_b32 v27, 0x0c0c0302
  v_mov_b32 v28, 0x03020c0c
  v_cndmask_b32 v27, v27, v28, vcc
  v_bfe_u32 v28, v0, 1, 2
  v_mov_b32 v29, 0x0c0c0c0c
  v_cmp_eq_u32 vcc, 0, v28
  s_nop 1
  v_cndmask_b32 v5, v29, v26, vcc
  v_cndmask_b32 v9, v29, v27, vcc
  v_cmp_eq_u32 vcc, 1, v28
  s_nop 1
  v_cndmask_b32 v6, v29, v26, vcc
  v_cndmask_b32 v10, v29, v27, vcc
  v_cmp_eq_u32 vcc, 2, v28
  s_nop 1
  v_cndmask_b32 v7, v29, v26, vcc
  v_cndmask_b32 v11, v29, v27, vcc
  v_cmp_eq_u32 vcc, 3, v28
  s_nop 1
  v_cndmask_b32 v8, v29, v26, vcc
  v_cndmask_b32 v12, v29, v27, vcc
  s_cmp_le_u32 s3, 2
  s_cselect_b32 s34, 2048, 0
  s_cselect_b32 s35, 0, 1073741824
  s_or_b32 s80, s80, s35
  v_mov_b32 v255, s34
  s_cmp_le_u32 s3, 2
  s_cselect_b32 s85, -1, 0x800000
  s_cselect_b32 s34, 0, 16
  v_add_u32 v4, s34, v252
  v_mov_b32 v13, 0xf149f2ca
  v_mov_b32 v14, 0x7191accb
  v_and_b32 v26, 0x23, v0
  v_bfe_u32 v27, v0, 2, 2
  v_lshl_add_u32 v26, v27, 3, v26
  v_bfe_u32 v27, v0, 4, 1
  v_lshl_add_u32 v26, v27, 2, v26
  v_lshlrev_b32 v249, 4, v26
  s_lshl_b32 s83, s2, 13
  s_lshl_b32 s34, s3, 10
  s_add_u32 s83, s83, s34
  s_add_u32 s83, s83, 2096128
  v_mov_b32 v15, 0
  v_mov_b32 v16, 0
  v_mov_b32 v17, 0
  v_mov_b32 v18, 0
  v_mov_b32 v19, 0
  v_bfe_u32 v27, v0, 3, 1
  v_lshlrev_b32 v52, 4, v27
  v_lshl_add_u32 v52, v25, 5, v52
  v_lshlrev_b32 v26, 8, v27
  v_lshl_add_u32 v26, v25, 6, v26
  v_and_b32 v27, 3, v0
  v_lshl_add_u32 v26, v27, 4, v26
  s_add_u32 s87, s64, 32768
  s_waitcnt vmcnt(1)
  buffer_load_dwordx4 v[80:83], v1, s[36:39], s87 offen offset:0 nt
  buffer_load_dwordx4 v[84:87], v1, s[36:39], s87 offen offset:1024 nt
  buffer_load_dwordx4 v[88:91], v1, s[36:39], s87 offen offset:2048 nt
  buffer_load_dwordx4 v[92:95], v1, s[36:39], s87 offen offset:3072 nt
  s_waitcnt vmcnt(1)
  buffer_load_dwordx4 v[96:99], v1, s[36:39], s65 offen offset:0 nt
  buffer_load_dwordx4 v[100:103], v1, s[36:39], s65 offen offset:1024 nt
  buffer_load_dwordx4 v[104:107], v1, s[36:39], s65 offen offset:2048 nt
  buffer_load_dwordx4 v[108:111], v1, s[36:39], s65 offen offset:3072 nt
  s_add_u32 s87, s65, 32768
  s_waitcnt vmcnt(1)
  buffer_load_dwordx4 v[112:115], v1, s[36:39], s87 offen offset:0 nt
  buffer_load_dwordx4 v[116:119], v1, s[36:39], s87 offen offset:1024 nt
  buffer_load_dwordx4 v[120:123], v1, s[36:39], s87 offen offset:2048 nt
  buffer_load_dwordx4 v[124:127], v1, s[36:39], s87 offen offset:3072 nt
  s_mov_b32 s86, 0
  s_cmp_le_u32 s3, 2
  s_cbranch_scc1 L_noxt
  s_mov_b32 s86, 1
  s_add_u32 s82, s3, 11
  s_lshl_b32 s82, s82, 12
  s_and_b32 s35, s82, 4294934528
  s_add_u32 s66, s82, s35
  s_xor_b32 s66, s66, s80
  s_and_b32 s66, s66, 0x7fffff
  s_add_u32 s82, s82, 20480
  s_add_u32 s87, s66, 32768
  s_waitcnt vmcnt(2)
  buffer_load_dwordx4 v[128:131], v1, s[36:39], s66 offen offset:0 nt
  buffer_load_dwordx4 v[132:135], v1, s[36:39], s66 offen offset:1024 nt
  buffer_load_dwordx4 v[136:139], v1, s[36:39], s66 offen offset:2048 nt
  buffer_load_dwordx4 v[140:143], v1, s[36:39], s66 offen offset:3072 nt
  s_waitcnt vmcnt(2)
  buffer_load_dwordx4 v[144:147], v1, s[36:39], s87 offen offset:0 nt
  buffer_load_dwordx4 v[148:151], v1, s[36:39], s87 offen offset:1024 nt
  buffer_load_dwordx4 v[152:155], v1, s[36:39], s87 offen offset:2048 nt
  buffer_load_dwordx4 v[156:159], v1, s[36:39], s87 offen offset:3072 nt
  s_and_b32 s35, s82, 4294934528
  s_add_u32 s67, s82, s35
  s_xor_b32 s67, s67, s80
  s_and_b32 s67, s67, 0x7fffff
  s_add_u32 s82, s82, 20480
  s_add_u32 s87, s67, 32768
  s_waitcnt vmcnt(2)
  buffer_load_dwordx4 v[160:163], v1, s[36:39], s67 offen offset:0 nt
  buffer_load_dwordx4 v[164:167], v1, s[36:39], s67 offen offset:1024 nt
  buffer_load_dwordx4 v[168:171], v1, s[36:39], s67 offen offset:2048 nt
  buffer_load_dwordx4 v[172:175], v1, s[36:39], s67 offen offset:3072 nt
  s_waitcnt vmcnt(2)
  buffer_load_dwordx4 v[176:179], v1, s[36:39], s87 offen offset:0 nt
  buffer_load_dwordx4 v[180:183], v1, s[36:39], s87 offen offset:1024 nt
  buffer_load_dwordx4 v[184:187], v1, s[36:39], s87 offen offset:2048 nt
  buffer_load_dwordx4 v[188:191], v1, s[36:39], s87 offen offset:3072 nt
  s_and_b32 s35, s82, 4294934528
  s_add_u32 s68, s82, s35
  s_xor_b32 s68, s68, s80
  s_and_b32 s68, s68, 0x7fffff
  s_add_u32 s82, s82, 20480
  s_add_u32 s87, s68, 32768
  s_waitcnt vmcnt(2)
  buffer_load_dwordx4 v[192:195], v1, s[36:39], s68 offen offset:0 nt
  buffer_load_dwordx4 v[196:199], v1, s[36:39], s68 offen offset:1024 nt
  buffer_load_dwordx4 v[200:203], v1, s[36:39], s68 offen offset:2048 nt
  buffer_load_dwordx4 v[204:207], v1, s[36:39], s68 offen offset:3072 nt
  s_waitcnt vmcnt(2)
  buffer_load_dwordx4 v[208:211], v1, s[36:39], s87 offen offset:0 nt
  buffer_load_dwordx4 v[212:215], v1, s[36:39], s87 offen offset:1024 nt
  buffer_load_dwordx4 v[216:219], v1, s[36:39], s87 offen offset:2048 nt
  buffer_load_dwordx4 v[220:223], v1, s[36:39], s87 offen offset:3072 nt
L_noxt:
L_qwait:
  ds_read_b32 v27, v252 offset:8
  s_waitcnt lgkmcnt(0)
  v_readfirstlane_b32 s34, v27
  s_cmp_eq_u32 s34, 1
  s_cbranch_scc1 L_qgot
  s_sleep 2
  s_branch L_qwait
L_qgot:
  ds_read_b128 v[48:51], v26 offset:0
  ds_read_b32 v254, v252 offset:28
  s_waitcnt lgkmcnt(0)
.p2align 6
L_loop:
L_t0:
  s_cmp_ge_u32 s64, 0x800000
  s_cbranch_scc1 L_done
  s_lshr_b32 s34, s64, 5
  s_and_b32 s34, s34, 0x7f80
  v_add_u32 v53, s34, v52
  s_and_b32 s81, s64, 3
  s_cmp_eq_u32 s81, 1
  s_cbranch_scc1 L_va0
  s_waitcnt vmcnt(12)
  s_cmp_eq_u32 s81, 2
  s_cbranch_scc1 L_ka0
  s_waitcnt vmcnt(8)
L_ka0:
  s_mov_b64 exec, 1
  ds_add_rtn_u32 v3, v4, v255
  s_mov_b64 exec, -1
  v_mfma_f32_16x16x32_bf16 v[24:27], v[64:67], v[48:51], 0
  v_mfma_f32_16x16x32_bf16 v[28:31], v[68:71], v[48:51], 0
  v_mfma_f32_16x16x32_bf16 v[32:35], v[72:75], v[48:51], 0
  v_mfma_f32_16x16x32_bf16 v[36:39], v[76:79], v[48:51], 0
  s_waitcnt lgkmcnt(0)
  v_readfirstlane_b32 s34, v3
  s_cmp_ge_u32 s34, 491520
  s_cbranch_scc1 L_poolk0
  s_cmp_ge_u32 s34, 245760
  s_cselect_b32 s35, 491519, 0
  s_lshl_b32 s34, s34, 1
  s_sub_u32 s34, s34, s35
  s_and_b32 s35, s34, 4294934528
  s_add_u32 s34, s34, s35
  s_xor_b32 s64, s34, s80
  s_and_b32 s84, s64, -4
  s_add_u32 s87, s84, 32768
L_pbackk0:
  s_cmp_ge_u32 s64, s85
  s_cbranch_scc1 L_skk0
  s_bitcmp1_b32 s64, 0
  s_cbranch_scc1 L_altk0
  buffer_load_dwordx4 v[64:67], v1, s[36:39], s84 offen offset:0 nt
  buffer_load_dwordx4 v[68:71], v1, s[36:39], s84 offen offset:1024 nt
  buffer_load_dwordx4 v[72:75], v1, s[36:39], s84 offen offset:2048 nt
  buffer_load_dwordx4 v[76:79], v1, s[36:39], s84 offen offset:3072 nt
L_skbk0:
  v_mov_b32_dpp v40, v24 quad_perm:[0,0,0,0] row_mask:0xf bank_mask:0xf
  v_mov_b32_dpp v41, v28 quad_perm:[0,0,0,0] row_mask:0xf bank_mask:0xf
  v_mov_b32_dpp v42, v32 quad_perm:[0,0,0,0] row_mask:0xf bank_mask:0xf
  v_mov_b32_dpp v43, v36 quad_perm:[0,0,0,0] row_mask:0xf bank_mask:0xf
  v_add_f32_dpp v40, v25, v40 quad_perm:[1,1,1,1] row_mask:0xf bank_mask:0xf
  v_add_f32_dpp v41, v29, v41 quad_perm:[1,1,1,1] row_mask:0xf bank_mask:0xf
  v_add_f32_dpp v42, v33, v42 quad_perm:[1,1,1,1] row_mask:0xf bank_mask:0xf
  v_add_f32_dpp v43, v37, v43 quad_perm:[1,1,1,1] row_mask:0xf bank_mask:0xf
  v_add_f32_dpp v40, v26, v40 quad_perm:[2,2,2,2] row_mask:0xf bank_mask:0xf
  v_add_f32_dpp v41, v30, v41 quad_perm:[2,2,2,2] row_mask:0xf bank_mask:0xf
  v_add_f32_dpp v42, v34, v42 quad_perm:[2,2,2,2] row_mask:0xf bank_mask:0xf
  v_add_f32_dpp v43, v38, v43 quad_perm:[2,2,2,2] row_mask:0xf bank_mask:0xf
  v_add_f32_dpp v40, v27, v40 quad_perm:[3,3,3,3] row_mask:0xf bank_mask:0xf
  v_add_f32_dpp v41, v31, v41 quad_perm:[3,3,3,3] row_mask:0xf bank_mask:0xf
  v_add_f32_dpp v42, v35, v42 quad_perm:[3,3,3,3] row_mask:0xf bank_mask:0xf
  v_add_f32_dpp v43, v39, v43 quad_perm:[3,3,3,3] row_mask:0xf bank_mask:0xf
  v_cvt_pk_bf16_f32 v40, v40, v41
  v_cvt_pk_bf16_f32 v42, v42, v43
  v_and_b32 v41, 0xffff0000, v40
  v_lshlrev_b32 v40, 16, v40
  v_and_b32 v43, 0xffff0000, v42
  v_lshlrev_b32 v42, 16, v42
  v_mul_f32 v40, s70, v40
  v_mul_f32 v41, s70, v41
  v_mul_f32 v42, s70, v42
  v_mul_f32 v43, s70, v43
  v_cvt_pk_bf16_f32 v22, v40, v41
  v_cvt_pk_bf16_f32 v23, v42, v43
  s_cmp_eq_u32 s81, 2
  s_cbranch_scc1 L_vb0
  s_waitcnt vmcnt(8)
  v_mfma_f32_16x16x32_bf16 v[24:27], v[80:83], v[48:51], 0
  v_mfma_f32_16x16x32_bf16 v[28:31], v[84:87], v[48:51], 0
  v_mfma_f32_16x16x32_bf16 v[32:35], v[88:91], v[48:51], 0
  v_mfma_f32_16x16x32_bf16 v[36:39], v[92:95], v[48:51], 0
  v_min_u32 v20, -2, v22
  v_mov_b32 v21, v23
  s_cmp_ge_u32 s64, s85
  s_cbranch_scc1 L_skck0
  s_and_b32 s34, s64, 3
  s_cbranch_scc1 L_albk0
  buffer_load_dwordx4 v[80:83], v1, s[36:39], s87 offen offset:0 nt
  buffer_load_dwordx4 v[84:87], v1, s[36:39], s87 offen offset:1024 nt
  buffer_load_dwordx4 v[88:91], v1, s[36:39], s87 offen offset:2048 nt
  buffer_load_dwordx4 v[92:95], v1, s[36:39], s87 offen offset:3072 nt
L_skdk0:
  v_mov_b32_dpp v40, v24 quad_perm:[0,0,0,0] row_mask:0xf bank_mask:0xf
  v_mov_b32_dpp v41, v28 quad_perm:[0,0,0,0] row_mask:0xf bank_mask:0xf
  v_mov_b32_dpp v42, v32 quad_perm:[0,0,0,0] row_mask:0xf bank_mask:0xf
  v_mov_b32_dpp v43, v36 quad_perm:[0,0,0,0] row_mask:0xf bank_mask:0xf
  v_add_f32_dpp v40, v25, v40 quad_perm:[1,1,1,1] row_mask:0xf bank_mask:0xf
  v_add_f32_dpp v41, v29, v41 quad_perm:[1,1,1,1] row_mask:0xf bank_mask:0xf
  v_add_f32_dpp v42, v33, v42 quad_perm:[1,1,1,1] row_mask:0xf bank_mask:0xf
  v_add_f32_dpp v43, v37, v43 quad_perm:[1,1,1,1] row_mask:0xf bank_mask:0xf
  v_add_f32_dpp v40, v26, v40 quad_perm:[2,2,2,2] row_mask:0xf bank_mask:0xf
  v_add_f32_dpp v41, v30, v41 quad_perm:[2,2,2,2] row_mask:0xf bank_mask:0xf
  v_add_f32_dpp v42, v34, v42 quad_perm:[2,2,2,2] row_mask:0xf bank_mask:0xf
  v_add_f32_dpp v43, v38, v43 quad_perm:[2,2,2,2] row_mask:0xf bank_mask:0xf
  v_add_f32_dpp v40, v27, v40 quad_perm:[3,3,3,3] row_mask:0xf bank_mask:0xf
  v_add_f32_dpp v41, v31, v41 quad_perm:[3,3,3,3] row_mask:0xf bank_mask:0xf
  v_add_f32_dpp v42, v35, v42 quad_perm:[3,3,3,3] row_mask:0xf bank_mask:0xf
  v_add_f32_dpp v43, v39, v43 quad_perm:[3,3,3,3] row_mask:0xf bank_mask:0xf
  v_cvt_pk_bf16_f32 v40, v40, v41
  v_cvt_pk_bf16_f32 v42, v42, v43
  v_and_b32 v41, 0xffff0000, v40
  v_lshlrev_b32 v40, 16, v40
  v_and_b32 v43, 0xffff0000, v42
  v_lshlrev_b32 v42, 16, v42
  v_mul_f32 v40, s70, v40
  v_mul_f32 v41, s70, v41
  v_mul_f32 v42, s70, v42
  v_mul_f32 v43, s70, v43
  v_cvt_pk_bf16_f32 v22, v40, v41
  v_cvt_pk_bf16_f32 v23, v42, v43
  v_min_u32 v23, -2, v23
  s_mov_b32 exec_lo, 0x01010101
  s_mov_b32 exec_hi, 0x01010101
  ds_write_b128 v53, v[20:23] offset:33280
  s_mov_b64 exec, -1
  s_branch L_t1
L_va0:
  s_mov_b32 s78, 0
L_vr0:
  ds_read_b128 v[20:23], v53 offset:33280
  s_waitcnt lgkmcnt(0)
  v_max_u32 v44, v20, v23
  v_cmp_eq_u32 vcc, -1, v44
  s_cbranch_vccnz L_vw0
L_vg0:
  v_and_b32 v41, 0xffff0000, v20
  v_lshlrev_b32 v40, 16, v20
  v_and_b32 v43, 0xffff0000, v21
  v_lshlrev_b32 v42, 16, v21
  v_max3_f32 v44, v40, v41, v42
  v_max_f32 v44, v44, v43
  v_cmp_gt_f32 vcc, v44, v13
  s_cbranch_vccnz L_rarea0
L_backa0:
  v_fma_f32 v40, v40, s71, v14
  v_fma_f32 v41, v41, s71, v14
  v_fma_f32 v42, v42, s71, v14
  v_fma_f32 v43, v43, s71, v14
  v_exp_f32 v40, v40
  v_exp_f32 v41, v41
  v_exp_f32 v42, v42
  v_exp_f32 v43, v43
  v_cvt_pk_bf16_f32 v46, v40, v41
  v_add_f32 v45, v40, v41
  v_cvt_pk_bf16_f32 v47, v42, v43
  v_add_f32 v44, v42, v43
  v_perm_b32 v24, v46, v46, v5
  v_perm_b32 v25, v46, v46, v6
  v_perm_b32 v26, v46, v46, v7
  v_perm_b32 v27, v46, v46, v8
  v_perm_b32 v28, v46, v46, v9
  v_perm_b32 v29, v46, v46, v10
  v_perm_b32 v30, v46, v46, v11
  v_perm_b32 v31, v46, v46, v12
  v_perm_b32 v32, v47, v47, v5
  v_perm_b32 v33, v47, v47, v6
  v_perm_b32 v34, v47, v47, v7
  v_perm_b32 v35, v47, v47, v8
  v_perm_b32 v36, v47, v47, v9
  v_perm_b32 v37, v47, v47, v10
  v_perm_b32 v38, v47, v47, v11
  v_perm_b32 v39, v47, v47, v12
  v_add_f32 v45, v45, v44
  v_add_f32 v15, v15, v45
  s_waitcnt vmcnt(8)
  s_mov_b64 exec, 1
  ds_add_rtn_u32 v3, v4, v255
  s_mov_b64 exec, -1
  v_mfma_f32_16x16x32_bf16 v[16:19], v[24:27], v[64:67], v[16:19]
  v_mfma_f32_16x16x32_bf16 v[16:19], v[28:31], v[68:71], v[16:19]
  v_mfma_f32_16x16x32_bf16 v[16:19], v[32:35], v[72:75], v[16:19]
  v_mfma_f32_16x16x32_bf16 v[16:19], v[36:39], v[76:79], v[16:19]
  s_waitcnt lgkmcnt(0)
  v_readfirstlane_b32 s34, v3
  s_cmp_ge_u32 s34, 491520
  s_cbranch_scc1 L_poolv0
  s_cmp_ge_u32 s34, 245760
  s_cselect_b32 s35, 491519, 0
  s_lshl_b32 s34, s34, 1
  s_sub_u32 s34, s34, s35
  s_and_b32 s35, s34, 4294934528
  s_add_u32 s34, s34, s35
  s_xor_b32 s64, s34, s80
  s_and_b32 s84, s64, -4
  s_add_u32 s87, s84, 32768
L_pbackv0:
  s_cmp_ge_u32 s64, s85
  s_cbranch_scc1 L_skv0
  s_bitcmp1_b32 s64, 0
  s_cbranch_scc0 L_altv0
  buffer_load_dwordx4 v[64:67], v2, s[40:43], s84 offen offset:0 nt
  buffer_load_dwordx4 v[68:71], v2, s[40:43], s84 offen offset:1024 nt
  buffer_load_dwordx4 v[72:75], v2, s[40:43], s84 offen offset:2048 nt
  buffer_load_dwordx4 v[76:79], v2, s[40:43], s84 offen offset:3072 nt
L_skbv0:
L_vb0:
  v_and_b32 v41, 0xffff0000, v22
  v_lshlrev_b32 v40, 16, v22
  v_and_b32 v43, 0xffff0000, v23
  v_lshlrev_b32 v42, 16, v23
  v_max3_f32 v44, v40, v41, v42
  v_max_f32 v44, v44, v43
  v_cmp_gt_f32 vcc, v44, v13
  s_cbranch_vccnz L_rareb0
L_backb0:
  v_fma_f32 v40, v40, s71, v14
  v_fma_f32 v41, v41, s71, v14
  v_fma_f32 v42, v42, s71, v14
  v_fma_f32 v43, v43, s71, v14
  v_exp_f32 v40, v40
  v_exp_f32 v41, v41
  v_exp_f32 v42, v42
  v_exp_f32 v43, v43
  v_cvt_pk_bf16_f32 v46, v40, v41
  v_add_f32 v45, v40, v41
  v_cvt_pk_bf16_f32 v47, v42, v43
  v_add_f32 v44, v42, v43
  v_perm_b32 v24, v46, v46, v5
  v_perm_b32 v25, v46, v46, v6
  v_perm_b32 v26, v46, v46, v7
  v_perm_b32 v27, v46, v46, v8
  v_perm_b32 v28, v46, v46, v9
  v_perm_b32 v29, v46, v46, v10
  v_perm_b32 v30, v46, v46, v11
  v_perm_b32 v31, v46, v46, v12
  v_perm_b32 v32, v47, v47, v5
  v_perm_b32 v33, v47, v47, v6
  v_perm_b32 v34, v47, v47, v7
  v_perm_b32 v35, v47, v47, v8
  v_perm_b32 v36, v47, v47, v9
  v_perm_b32 v37, v47, v47, v10
  v_perm_b32 v38, v47, v47, v11
  v_perm_b32 v39, v47, v47, v12
  v_add_f32 v45, v45, v44
  v_add_f32 v15, v15, v45
  s_waitcnt vmcnt(12)
  s_cmp_eq_u32 s81, 2
  s_cbranch_scc1 L_vc0
  s_waitcnt vmcnt(8)
L_vc0:
  v_mfma_f32_16x16x32_bf16 v[16:19], v[24:27], v[80:83], v[16:19]
  v_mfma_f32_16x16x32_bf16 v[16:19], v[28:31], v[84:87], v[16:19]
  v_mfma_f32_16x16x32_bf16 v[16:19], v[32:35], v[88:91], v[16:19]
  v_mfma_f32_16x16x32_bf16 v[16:19], v[36:39], v[92:95], v[16:19]
  s_cmp_ge_u32 s64, s85
  s_cbranch_scc1 L_skcv0
  s_and_b32 s34, s64, 3
  s_cbranch_scc0 L_albv0
  buffer_load_dwordx4 v[80:83], v2, s[40:43], s87 offen offset:0 nt
  buffer_load_dwordx4 v[84:87], v2, s[40:43], s87 offen offset:1024 nt
  buffer_load_dwordx4 v[88:91], v2, s[40:43], s87 offen offset:2048 nt
  buffer_load_dwordx4 v[92:95], v2, s[40:43], s87 offen offset:3072 nt
L_skdv0:
L_t1:
  s_cmp_ge_u32 s65, 0x800000
  s_cbranch_scc1 L_done
  s_lshr_b32 s34, s65, 5
  s_and_b32 s34, s34, 0x7f80
  v_add_u32 v53, s34, v52
  s_and_b32 s81, s65, 3
  s_cmp_eq_u32 s81, 1
  s_cbranch_scc1 L_va1
  s_waitcnt vmcnt(12)
  s_cmp_eq_u32 s81, 2
  s_cbranch_scc1 L_ka1
  s_waitcnt vmcnt(8)
L_ka1:
  s_mov_b64 exec, 1
  ds_add_rtn_u32 v3, v4, v255
  s_mov_b64 exec, -1
  v_mfma_f32_16x16x32_bf16 v[24:27], v[96:99], v[48:51], 0
  v_mfma_f32_16x16x32_bf16 v[28:31], v[100:103], v[48:51], 0
  v_mfma_f32_16x16x32_bf16 v[32:35], v[104:107], v[48:51], 0
  v_mfma_f32_16x16x32_bf16 v[36:39], v[108:111], v[48:51], 0
  s_waitcnt lgkmcnt(0)
  v_readfirstlane_b32 s34, v3
  s_cmp_ge_u32 s34, 491520
  s_cbranch_scc1 L_poolk1
  s_cmp_ge_u32 s34, 245760
  s_cselect_b32 s35, 491519, 0
  s_lshl_b32 s34, s34, 1
  s_sub_u32 s34, s34, s35
  s_and_b32 s35, s34, 4294934528
  s_add_u32 s34, s34, s35
  s_xor_b32 s65, s34, s80
  s_and_b32 s84, s65, -4
  s_add_u32 s87, s84, 32768
L_pbackk1:
  s_cmp_ge_u32 s65, s85
  s_cbranch_scc1 L_skk1
  s_bitcmp1_b32 s65, 0
  s_cbranch_scc1 L_altk1
  buffer_load_dwordx4 v[96:99], v1, s[36:39], s84 offen offset:0 nt
  buffer_load_dwordx4 v[100:103], v1, s[36:39], s84 offen offset:1024 nt
  buffer_load_dwordx4 v[104:107], v1, s[36:39], s84 offen offset:2048 nt
  buffer_load_dwordx4 v[108:111], v1, s[36:39], s84 offen offset:3072 nt
L_skbk1:
  v_mov_b32_dpp v40, v24 quad_perm:[0,0,0,0] row_mask:0xf bank_mask:0xf
  v_mov_b32_dpp v41, v28 quad_perm:[0,0,0,0] row_mask:0xf bank_mask:0xf
  v_mov_b32_dpp v42, v32 quad_perm:[0,0,0,0] row_mask:0xf bank_mask:0xf
  v_mov_b32_dpp v43, v36 quad_perm:[0,0,0,0] row_mask:0xf bank_mask:0xf
  v_add_f32_dpp v40, v25, v40 quad_perm:[1,1,1,1] row_mask:0xf bank_mask:0xf
  v_add_f32_dpp v41, v29, v41 quad_perm:[1,1,1,1] row_mask:0xf bank_mask:0xf
  v_add_f32_dpp v42, v33, v42 quad_perm:[1,1,1,1] row_mask:0xf bank_mask:0xf
  v_add_f32_dpp v43, v37, v43 quad_perm:[1,1,1,1] row_mask:0xf bank_mask:0xf
  v_add_f32_dpp v40, v26, v40 quad_perm:[2,2,2,2] row_mask:0xf bank_mask:0xf
  v_add_f32_dpp v41, v30, v41 quad_perm:[2,2,2,2] row_mask:0xf bank_mask:0xf
  v_add_f32_dpp v42, v34, v42 quad_perm:[2,2,2,2] row_mask:0xf bank_mask:0xf
  v_add_f32_dpp v43, v38, v43 quad_perm:[2,2,2,2] row_mask:0xf bank_mask:0xf
  v_add_f32_dpp v40, v27, v40 quad_perm:[3,3,3,3] row_mask:0xf bank_mask:0xf
  v_add_f32_dpp v41, v31, v41 quad_perm:[3,3,3,3] row_mask:0xf bank_mask:0xf
  v_add_f32_dpp v42, v35, v42 quad_perm:[3,3,3,3] row_mask:0xf bank_mask:0xf
  v_add_f32_dpp v43, v39, v43 quad_perm:[3,3,3,3] row_mask:0xf bank_mask:0xf
  v_cvt_pk_bf16_f32 v40, v40, v41
  v_cvt_pk_bf16_f32 v42, v42, v43
  v_and_b32 v41, 0xffff0000, v40
  v_lshlrev_b32 v40, 16, v40
  v_and_b32 v43, 0xffff0000, v42
  v_lshlrev_b32 v42, 16, v42
  v_mul_f32 v40, s70, v40
  v_mul_f32 v41, s70, v41
  v_mul_f32 v42, s70, v42
  v_mul_f32 v43, s70, v43
  v_cvt_pk_bf16_f32 v22, v40, v41
  v_cvt_pk_bf16_f32 v23, v42, v43
  s_cmp_eq_u32 s81, 2
  s_cbranch_scc1 L_vb1
  s_waitcnt vmcnt(8)
  v_mfma_f32_16x16x32_bf16 v[24:27], v[112:115], v[48:51], 0
  v_mfma_f32_16x16x32_bf16 v[28:31], v[116:119], v[48:51], 0
  v_mfma_f32_16x16x32_bf16 v[32:35], v[120:123], v[48:51], 0
  v_mfma_f32_16x16x32_bf16 v[36:39], v[124:127], v[48:51], 0
  v_min_u32 v20, -2, v22
  v_mov_b32 v21, v23
  s_cmp_ge_u32 s65, s85
  s_cbranch_scc1 L_skck1
  s_and_b32 s34, s65, 3
  s_cbranch_scc1 L_albk1
  buffer_load_dwordx4 v[112:115], v1, s[36:39], s87 offen offset:0 nt
  buffer_load_dwordx4 v[116:119], v1, s[36:39], s87 offen offset:1024 nt
  buffer_load_dwordx4 v[120:123], v1, s[36:39], s87 offen offset:2048 nt
  buffer_load_dwordx4 v[124:127], v1, s[36:39], s87 offen offset:3072 nt
L_skdk1:
  v_mov_b32_dpp v40, v24 quad_perm:[0,0,0,0] row_mask:0xf bank_mask:0xf
  v_mov_b32_dpp v41, v28 quad_perm:[0,0,0,0] row_mask:0xf bank_mask:0xf
  v_mov_b32_dpp v42, v32 quad_perm:[0,0,0,0] row_mask:0xf bank_mask:0xf
  v_mov_b32_dpp v43, v36 quad_perm:[0,0,0,0] row_mask:0xf bank_mask:0xf
  v_add_f32_dpp v40, v25, v40 quad_perm:[1,1,1,1] row_mask:0xf bank_mask:0xf
  v_add_f32_dpp v41, v29, v41 quad_perm:[1,1,1,1] row_mask:0xf bank_mask:0xf
  v_add_f32_dpp v42, v33, v42 quad_perm:[1,1,1,1] row_mask:0xf bank_mask:0xf
  v_add_f32_dpp v43, v37, v43 quad_perm:[1,1,1,1] row_mask:0xf bank_mask:0xf
  v_add_f32_dpp v40, v26, v40 quad_perm:[2,2,2,2] row_mask:0xf bank_mask:0xf
  v_add_f32_dpp v41, v30, v41 quad_perm:[2,2,2,2] row_mask:0xf bank_mask:0xf
  v_add_f32_dpp v42, v34, v42 quad_perm:[2,2,2,2] row_mask:0xf bank_mask:0xf
  v_add_f32_dpp v43, v38, v43 quad_perm:[2,2,2,2] row_mask:0xf bank_mask:0xf
  v_add_f32_dpp v40, v27, v40 quad_perm:[3,3,3,3] row_mask:0xf bank_mask:0xf
  v_add_f32_dpp v41, v31, v41 quad_perm:[3,3,3,3] row_mask:0xf bank_mask:0xf
  v_add_f32_dpp v42, v35, v42 quad_perm:[3,3,3,3] row_mask:0xf bank_mask:0xf
  v_add_f32_dpp v43, v39, v43 quad_perm:[3,3,3,3] row_mask:0xf bank_mask:0xf
  v_cvt_pk_bf16_f32 v40, v40, v41
  v_cvt_pk_bf16_f32 v42, v42, v43
  v_and_b32 v41, 0xffff0000, v40
  v_lshlrev_b32 v40, 16, v40
  v_and_b32 v43, 0xffff0000, v42
  v_lshlrev_b32 v42, 16, v42
  v_mul_f32 v40, s70, v40
  v_mul_f32 v41, s70, v41
  v_mul_f32 v42, s70, v42
  v_mul_f32 v43, s70, v43
  v_cvt_pk_bf16_f32 v22, v40, v41
  v_cvt_pk_bf16_f32 v23, v42, v43
  v_min_u32 v23, -2, v23
  s_mov_b32 exec_lo, 0x01010101
  s_mov_b32 exec_hi, 0x01010101
  ds_write_b128 v53, v[20:23] offset:33280
  s_mov_b64 exec, -1
  s_branch L_t0
L_va1:
  s_mov_b32 s78, 0
L_vr1:
  ds_read_b128 v[20:23], v53 offset:33280
  s_waitcnt lgkmcnt(0)
  v_max_u32 v44, v20, v23
  v_cmp_eq_u32 vcc, -1, v44
  s_cbranch_vccnz L_vw1
L_vg1:
  v_and_b32 v41, 0xffff0000, v20
  v_lshlrev_b32 v40, 16, v20
  v_and_b32 v43, 0xffff0000, v21
  v_lshlrev_b32 v42, 16, v21
  v_max3_f32 v44, v40, v41, v42
  v_max_f32 v44, v44, v43
  v_cmp_gt_f32 vcc, v44, v13
  s_cbranch_vccnz L_rarea1
L_backa1:
  v_fma_f32 v40, v40, s71, v14
  v_fma_f32 v41, v41, s71, v14
  v_fma_f32 v42, v42, s71, v14
  v_fma_f32 v43, v43, s71, v14
  v_exp_f32 v40, v40
  v_exp_f32 v41, v41
  v_exp_f32 v42, v42
  v_exp_f32 v43, v43
  v_cvt_pk_bf16_f32 v46, v40, v41
  v_add_f32 v45, v40, v41
  v_cvt_pk_bf16_f32 v47, v42, v43
  v_add_f32 v44, v42, v43
  v_perm_b32 v24, v46, v46, v5
  v_perm_b32 v25, v46, v46, v6
  v_perm_b32 v26, v46, v46, v7
  v_perm_b32 v27, v46, v46, v8
  v_perm_b32 v28, v46, v46, v9
  v_perm_b32 v29, v46, v46, v10
  v_perm_b32 v30, v46, v46, v11
  v_perm_b32 v31, v46, v46, v12
  v_perm_b32 v32, v47, v47, v5
  v_perm_b32 v33, v47, v47, v6
  v_perm_b32 v34, v47, v47, v7
  v_perm_b32 v35, v47, v47, v8
  v_perm_b32 v36, v47, v47, v9
  v_perm_b32 v37, v47, v47, v10
  v_perm_b32 v38, v47, v47, v11
  v_perm_b32 v39, v47, v47, v12
  v_add_f32 v45, v45, v44
  v_add_f32 v15, v15, v45
  s_waitcnt vmcnt(8)
  s_mov_b64 exec, 1
  ds_add_rtn_u32 v3, v4, v255
  s_mov_b64 exec, -1
  v_mfma_f32_16x16x32_bf16 v[16:19], v[24:27], v[96:99], v[16:19]
  v_mfma_f32_16x16x32_bf16 v[16:19], v[28:31], v[100:103], v[16:19]
  v_mfma_f32_16x16x32_bf16 v[16:19], v[32:35], v[104:107], v[16:19]
  v_mfma_f32_16x16x32_bf16 v[16:19], v[36:39], v[108:111], v[16:19]
  s_waitcnt lgkmcnt(0)
  v_readfirstlane_b32 s34, v3
  s_cmp_ge_u32 s34, 491520
  s_cbranch_scc1 L_poolv1
  s_cmp_ge_u32 s34, 245760
  s_cselect_b32 s35, 491519, 0
  s_lshl_b32 s34, s34, 1
  s_sub_u32 s34, s34, s35
  s_and_b32 s35, s34, 4294934528
  s_add_u32 s34, s34, s35
  s_xor_b32 s65, s34, s80
  s_and_b32 s84, s65, -4
  s_add_u32 s87, s84, 32768
L_pbackv1:
  s_cmp_ge_u32 s65, s85
  s_cbranch_scc1 L_skv1
  s_bitcmp1_b32 s65, 0
  s_cbranch_scc0 L_altv1
  buffer_load_dwordx4 v[96:99], v2, s[40:43], s84 offen offset:0 nt
  buffer_load_dwordx4 v[100:103], v2, s[40:43], s84 offen offset:1024 nt
  buffer_load_dwordx4 v[104:107], v2, s[40:43], s84 offen offset:2048 nt
  buffer_load_dwordx4 v[108:111], v2, s[40:43], s84 offen offset:3072 nt
L_skbv1:
L_vb1:
  v_and_b32 v41, 0xffff0000, v22
  v_lshlrev_b32 v40, 16, v22
  v_and_b32 v43, 0xffff0000, v23
  v_lshlrev_b32 v42, 16, v23
  v_max3_f32 v44, v40, v41, v42
  v_max_f32 v44, v44, v43
  v_cmp_gt_f32 vcc, v44, v13
  s_cbranch_vccnz L_rareb1
L_backb1:
  v_fma_f32 v40, v40, s71, v14
  v_fma_f32 v41, v41, s71, v14
  v_fma_f32 v42, v42, s71, v14
  v_fma_f32 v43, v43, s71, v14
  v_exp_f32 v40, v40
  v_exp_f32 v41, v41
  v_exp_f32 v42, v42
  v_exp_f32 v43, v43
  v_cvt_pk_bf16_f32 v46, v40, v41
  v_add_f32 v45, v40, v41
  v_cvt_pk_bf16_f32 v47, v42, v43
  v_add_f32 v44, v42, v43
  v_perm_b32 v24, v46, v46, v5
  v_perm_b32 v25, v46, v46, v6
  v_perm_b32 v26, v46, v46, v7
  v_perm_b32 v27, v46, v46, v8
  v_perm_b32 v28, v46, v46, v9
  v_perm_b32 v29, v46, v46, v10
  v_perm_b32 v30, v46, v46, v11
  v_perm_b32 v31, v46, v46, v12
  v_perm_b32 v32, v47, v47, v5
  v_perm_b32 v33, v47, v47, v6
  v_perm_b32 v34, v47, v47, v7
  v_perm_b32 v35, v47, v47, v8
  v_perm_b32 v36, v47, v47, v9
  v_perm_b32 v37, v47, v47, v10
  v_perm_b32 v38, v47, v47, v11
  v_perm_b32 v39, v47, v47, v12
  v_add_f32 v45, v45, v44
  v_add_f32 v15, v15, v45
  s_waitcnt vmcnt(12)
  s_cmp_eq_u32 s81, 2
  s_cbranch_scc1 L_vc1
  s_waitcnt vmcnt(8)
L_vc1:
  v_mfma_f32_16x16x32_bf16 v[16:19], v[24:27], v[112:115], v[16:19]
  v_mfma_f32_16x16x32_bf16 v[16:19], v[28:31], v[116:119], v[16:19]
  v_mfma_f32_16x16x32_bf16 v[16:19], v[32:35], v[120:123], v[16:19]
  v_mfma_f32_16x16x32_bf16 v[16:19], v[36:39], v[124:127], v[16:19]
  s_cmp_ge_u32 s65, s85
  s_cbranch_scc1 L_skcv1
  s_and_b32 s34, s65, 3
  s_cbranch_scc0 L_albv1
  buffer_load_dwordx4 v[112:115], v2, s[40:43], s87 offen offset:0 nt
  buffer_load_dwordx4 v[116:119], v2, s[40:43], s87 offen offset:1024 nt
  buffer_load_dwordx4 v[120:123], v2, s[40:43], s87 offen offset:2048 nt
  buffer_load_dwordx4 v[124:127], v2, s[40:43], s87 offen offset:3072 nt
L_skdv1:
  s_branch L_loop
L_altk0:
  buffer_load_dwordx4 v[64:67], v2, s[40:43], s84 offen offset:0 nt
  buffer_load_dwordx4 v[68:71], v2, s[40:43], s84 offen offset:1024 nt
  buffer_load_dwordx4 v[72:75], v2, s[40:43], s84 offen offset:2048 nt
  buffer_load_dwordx4 v[76:79], v2, s[40:43], s84 offen offset:3072 nt
  s_branch L_skbk0
L_skk0:
  s_waitcnt vmcnt(0)
  s_branch L_skbk0
L_poolk0:
  s_sub_u32 s34, s34, 491520
  s_lshr_b32 s34, s34, 9
  v_mov_b32 v44, s34
L_pspink0:
  ds_read_b32 v3, v44 offset:12288
  s_waitcnt lgkmcnt(0)
  v_readfirstlane_b32 s35, v3
  s_mov_b32 s64, s35
  s_and_b32 s84, s35, -4
  s_mov_b32 s87, s84
  s_cmp_lg_u32 s35, -1
  s_cbranch_scc1 L_pbackk0
  s_sleep 1
  s_branch L_pspink0
L_albk0:
  buffer_load_dwordx4 v[80:83], v2, s[40:43], s87 offen offset:0 nt
  buffer_load_dwordx4 v[84:87], v2, s[40:43], s87 offen offset:1024 nt
  buffer_load_dwordx4 v[88:91], v2, s[40:43], s87 offen offset:2048 nt
  buffer_load_dwordx4 v[92:95], v2, s[40:43], s87 offen offset:3072 nt
  s_branch L_skdk0
L_skck0:
  s_nop 3
  s_branch L_skdk0
L_vw0:
  s_sleep 1
  s_add_u32 s78, s78, 1
  s_cmp_lt_u32 s78, 0x100000
  s_cbranch_scc1 L_vr0
  s_branch L_vg0
L_rarea0:
  v_mov_b32 v45, v44
  s_nop 1
  v_permlane32_swap_b32 v45, v44
  v_max_f32 v44, v44, v45
  v_mov_b32 v45, v44
  s_nop 1
  v_permlane16_swap_b32 v45, v44
  v_max_f32 v44, v44, v45
  v_max_f32 v44, v44, v13
  v_sub_f32 v45, v13, v44
  v_mul_f32 v45, s71, v45
  v_exp_f32 v45, v45
  v_mov_b32 v13, v44
  v_mul_f32 v14, s72, v44
  v_mul_f32 v15, v15, v45
  v_mov_b32_dpp v44, v45 row_ror:8 row_mask:0xf bank_mask:0xf
  v_cndmask_b32 v44, v44, v45, s[74:75]
  v_mul_f32 v16, v16, v44
  v_mul_f32 v17, v17, v44
  v_mul_f32 v18, v18, v44
  v_mul_f32 v19, v19, v44
  s_branch L_backa0
L_altv0:
  buffer_load_dwordx4 v[64:67], v1, s[36:39], s84 offen offset:0 nt
  buffer_load_dwordx4 v[68:71], v1, s[36:39], s84 offen offset:1024 nt
  buffer_load_dwordx4 v[72:75], v1, s[36:39], s84 offen offset:2048 nt
  buffer_load_dwordx4 v[76:79], v1, s[36:39], s84 offen offset:3072 nt
  s_branch L_skbv0
L_skv0:
  s_waitcnt vmcnt(0)
  s_branch L_skbv0
L_poolv0:
  s_sub_u32 s34, s34, 491520
  s_lshr_b32 s34, s34, 9
  v_mov_b32 v44, s34
L_pspinv0:
  ds_read_b32 v3, v44 offset:12288
  s_waitcnt lgkmcnt(0)
  v_readfirstlane_b32 s35, v3
  s_mov_b32 s64, s35
  s_and_b32 s84, s35, -4
  s_mov_b32 s87, s84
  s_cmp_lg_u32 s35, -1
  s_cbranch_scc1 L_pbackv0
  s_sleep 1
  s_branch L_pspinv0
L_rareb0:
  v_mov_b32 v45, v44
  s_nop 1
  v_permlane32_swap_b32 v45, v44
  v_max_f32 v44, v44, v45
  v_mov_b32 v45, v44
  s_nop 1
  v_permlane16_swap_b32 v45, v44
  v_max_f32 v44, v44, v45
  v_max_f32 v44, v44, v13
  v_sub_f32 v45, v13, v44
  v_mul_f32 v45, s71, v45
  v_exp_f32 v45, v45
  v_mov_b32 v13, v44
  v_mul_f32 v14, s72, v44
  v_mul_f32 v15, v15, v45
  v_mov_b32_dpp v44, v45 row_ror:8 row_mask:0xf bank_mask:0xf
  v_cndmask_b32 v44, v44, v45, s[74:75]
  v_mul_f32 v16, v16, v44
  v_mul_f32 v17, v17, v44
  v_mul_f32 v18, v18, v44
  v_mul_f32 v19, v19, v44
  s_branch L_backb0
L_albv0:
  buffer_load_dwordx4 v[80:83], v1, s[36:39], s87 offen offset:0 nt
  buffer_load_dwordx4 v[84:87], v1, s[36:39], s87 offen offset:1024 nt
  buffer_load_dwordx4 v[88:91], v1, s[36:39], s87 offen offset:2048 nt
  buffer_load_dwordx4 v[92:95], v1, s[36:39], s87 offen offset:3072 nt
  s_branch L_skdv0
L_skcv0:
  s_nop 3
  s_branch L_skdv0
L_altk1:
  buffer_load_dwordx4 v[96:99], v2, s[40:43], s84 offen offset:0 nt
  buffer_load_dwordx4 v[100:103], v2, s[40:43], s84 offen offset:1024 nt
  buffer_load_dwordx4 v[104:107], v2, s[40:43], s84 offen offset:2048 nt
  buffer_load_dwordx4 v[108:111], v2, s[40:43], s84 offen offset:3072 nt
  s_branch L_skbk1
L_skk1:
  s_waitcnt vmcnt(0)
  s_branch L_skbk1
L_poolk1:
  s_sub_u32 s34, s34, 491520
  s_lshr_b32 s34, s34, 9
  v_mov_b32 v44, s34
L_pspink1:
  ds_read_b32 v3, v44 offset:12288
  s_waitcnt lgkmcnt(0)
  v_readfirstlane_b32 s35, v3
  s_mov_b32 s65, s35
  s_and_b32 s84, s35, -4
  s_mov_b32 s87, s84
  s_cmp_lg_u32 s35, -1
  s_cbranch_scc1 L_pbackk1
  s_sleep 1
  s_branch L_pspink1
L_albk1:
  buffer_load_dwordx4 v[112:115], v2, s[40:43], s87 offen offset:0 nt
  buffer_load_dwordx4 v[116:119], v2, s[40:43], s87 offen offset:1024 nt
  buffer_load_dwordx4 v[120:123], v2, s[40:43], s87 offen offset:2048 nt
  buffer_load_dwordx4 v[124:127], v2, s[40:43], s87 offen offset:3072 nt
  s_branch L_skdk1
L_skck1:
  s_nop 3
  s_branch L_skdk1
L_vw1:
  s_sleep 1
  s_add_u32 s78, s78, 1
  s_cmp_lt_u32 s78, 0x100000
  s_cbranch_scc1 L_vr1
  s_branch L_vg1
L_rarea1:
  v_mov_b32 v45, v44
  s_nop 1
  v_permlane32_swap_b32 v45, v44
  v_max_f32 v44, v44, v45
  v_mov_b32 v45, v44
  s_nop 1
  v_permlane16_swap_b32 v45, v44
  v_max_f32 v44, v44, v45
  v_max_f32 v44, v44, v13
  v_sub_f32 v45, v13, v44
  v_mul_f32 v45, s71, v45
  v_exp_f32 v45, v45
  v_mov_b32 v13, v44
  v_mul_f32 v14, s72, v44
  v_mul_f32 v15, v15, v45
  v_mov_b32_dpp v44, v45 row_ror:8 row_mask:0xf bank_mask:0xf
  v_cndmask_b32 v44, v44, v45, s[74:75]
  v_mul_f32 v16, v16, v44
  v_mul_f32 v17, v17, v44
  v_mul_f32 v18, v18, v44
  v_mul_f32 v19, v19, v44
  s_branch L_backa1
L_altv1:
  buffer_load_dwordx4 v[96:99], v1, s[36:39], s84 offen offset:0 nt
  buffer_load_dwordx4 v[100:103], v1, s[36:39], s84 offen offset:1024 nt
  buffer_load_dwordx4 v[104:107], v1, s[36:39], s84 offen offset:2048 nt
  buffer_load_dwordx4 v[108:111], v1, s[36:39], s84 offen offset:3072 nt
  s_branch L_skbv1
L_skv1:
  s_waitcnt vmcnt(0)
  s_branch L_skbv1
L_poolv1:
  s_sub_u32 s34, s34, 491520
  s_lshr_b32 s34, s34, 9
  v_mov_b32 v44, s34
L_pspinv1:
  ds_read_b32 v3, v44 offset:12288
  s_waitcnt lgkmcnt(0)
  v_readfirstlane_b32 s35, v3
  s_mov_b32 s65, s35
  s_and_b32 s84, s35, -4
  s_mov_b32 s87, s84
  s_cmp_lg_u32 s35, -1
  s_cbranch_scc1 L_pbackv1
  s_sleep 1
  s_branch L_pspinv1
L_rareb1:
  v_mov_b32 v45, v44
  s_nop 1
  v_permlane32_swap_b32 v45, v44
  v_max_f32 v44, v44, v45
  v_mov_b32 v45, v44
  s_nop 1
  v_permlane16_swap_b32 v45, v44
  v_max_f32 v44, v44, v45
  v_max_f32 v44, v44, v13
  v_sub_f32 v45, v13, v44
  v_mul_f32 v45, s71, v45
  v_exp_f32 v45, v45
  v_mov_b32 v13, v44
  v_mul_f32 v14, s72, v44
  v_mul_f32 v15, v15, v45
  v_mov_b32_dpp v44, v45 row_ror:8 row_mask:0xf bank_mask:0xf
  v_cndmask_b32 v44, v44, v45, s[74:75]
  v_mul_f32 v16, v16, v44
  v_mul_f32 v17, v17, v44
  v_mul_f32 v18, v18, v44
  v_mul_f32 v19, v19, v44
  s_branch L_backb1
L_albv1:
  buffer_load_dwordx4 v[112:115], v1, s[36:39], s87 offen offset:0 nt
  buffer_load_dwordx4 v[116:119], v1, s[36:39], s87 offen offset:1024 nt
  buffer_load_dwordx4 v[120:123], v1, s[36:39], s87 offen offset:2048 nt
  buffer_load_dwordx4 v[124:127], v1, s[36:39], s87 offen offset:3072 nt
  s_branch L_skdv1
L_skcv1:
  s_nop 3
  s_branch L_skdv1
.p2align 6
L_helper:
  s_setprio 3
  v_bfe_u32 v26, v0, 3, 1
  v_mul_u32_u24 v26, 1152, v26
  v_and_b32 v28, 7, v0
  v_lshl_add_u32 v28, v25, 3, v28
  v_mad_u32_u24 v28, v28, 36, v26
  v_mad_u32_u24 v29, v25, 36, v26
  v_mul_u32_u24 v30, 0x24000, v25
  v_add_u32 v30, v30, v27
  v_lshlrev_b32 v31, 1, v0
  v_mov_b32 v32, 59392
  v_mov_b32 v33, -1
  v_mov_b32 v34, 0
  v_mov_b32 v35, 0
  ds_write_b128 v252, v[32:35]
  v_mov_b32 v36, 0
  ds_write_b96 v252, v[34:36] offset:16
  s_lshl_b32 s82, s31, 3
  s_or_b32 s82, s82, s32
  s_lshr_b32 s80, s82, 1
  s_and_b32 s81, s82, 1
  s_mul_i32 s35, s80, 144
  s_mul_i32 s34, s80, 589824
  s_lshl_b32 s83, s30, 9
  s_add_u32 s34, s34, s83
  s_lshl_b32 s83, s81, 8
  s_add_u32 s34, s34, s83
  s_mov_b32 s46, 2304
  s_mov_b32 s47, 0x20000
  s_mov_b32 s50, 4718592
  s_mov_b32 s51, 0x20000
  s_mov_b32 s58, 4194560
  s_mov_b32 s59, 0x20000
  s_waitcnt lgkmcnt(0)
  s_mov_b32 s44, s4
  s_and_b32 s45, s5, 0xffff
  s_mov_b32 s48, s10
  s_and_b32 s49, s11, 0xffff
  s_mov_b32 s56, s28
  s_and_b32 s57, s29, 0xffff
  buffer_load_dwordx4 v[64:67], v28, s[44:47], 0 offen
  buffer_load_dwordx4 v[68:71], v28, s[44:47], 0 offen offset:16
  buffer_load_dword v72, v28, s[44:47], 0 offen offset:32
  buffer_load_dwordx4 v[74:77], v29, s[44:47], s35 offen
  buffer_load_dwordx4 v[78:81], v29, s[44:47], s35 offen offset:16
  buffer_load_dword v82, v29, s[44:47], s35 offen offset:32
  buffer_load_dwordx4 v[104:107], v30, s[48:51], s34 offen nt
  s_add_u32 s34, s34, 8192
  buffer_load_dwordx4 v[108:111], v30, s[48:51], s34 offen nt
  s_add_u32 s34, s34, 8192
  buffer_load_dwordx4 v[112:115], v30, s[48:51], s34 offen nt
  s_add_u32 s34, s34, 8192
  buffer_load_dwordx4 v[116:119], v30, s[48:51], s34 offen nt
  s_add_u32 s34, s34, 8192
  buffer_load_dwordx4 v[120:123], v30, s[48:51], s34 offen nt
  s_add_u32 s34, s34, 8192
  buffer_load_dwordx4 v[124:127], v30, s[48:51], s34 offen nt
  s_add_u32 s34, s34, 8192
  buffer_load_dwordx4 v[128:131], v30, s[48:51], s34 offen nt
  s_add_u32 s34, s34, 8192
  buffer_load_dwordx4 v[132:135], v30, s[48:51], s34 offen nt
  s_add_u32 s34, s34, 8192
  buffer_load_dwordx4 v[136:139], v30, s[48:51], s34 offen nt
  s_add_u32 s34, s34, 8192
  buffer_load_dwordx4 v[140:143], v30, s[48:51], s34 offen nt
  s_add_u32 s34, s34, 8192
  buffer_load_dwordx4 v[144:147], v30, s[48:51], s34 offen nt
  s_add_u32 s34, s34, 8192
  buffer_load_dwordx4 v[148:151], v30, s[48:51], s34 offen nt
  s_add_u32 s34, s34, 8192
  buffer_load_dwordx4 v[152:155], v30, s[48:51], s34 offen nt
  s_add_u32 s34, s34, 8192
  buffer_load_dwordx4 v[156:159], v30, s[48:51], s34 offen nt
  s_add_u32 s34, s34, 8192
  buffer_load_dwordx4 v[160:163], v30, s[48:51], s34 offen nt
  s_add_u32 s34, s34, 8192
  buffer_load_dwordx4 v[164:167], v30, s[48:51], s34 offen nt
  s_add_u32 s34, s34, 8192
  buffer_load_dwordx4 v[168:171], v30, s[48:51], s34 offen nt
  s_add_u32 s34, s34, 8192
  buffer_load_dwordx4 v[172:175], v30, s[48:51], s34 offen nt
  s_barrier
  s_load_dword s76, s[28:29], 0
  s_add_u32 s84, s28, 4194304
  s_addc_u32 s85, s29, 0
  s_load_dword s78, s[84:85], 0
  s_load_dword s79, s[22:23], 0
  s_mul_i32 s86, s77, 57
  s_lshr_b32 s86, s86, 9
  s_mul_i32 s34, s86, 9
  s_sub_u32 s87, s77, s34
  s_min_u32 s86, s86, 11
  s_mul_i32 s34, s86, 768
  s_add_u32 s35, s34, 64
  s_load_dword s64, s[16:17], s34
  s_load_dword s65, s[16:17], s35
  s_load_dword s66, s[18:19], s34
  s_load_dword s67, s[18:19], s35
  s_load_dword s68, s[20:21], s34
  s_load_dword s69, s[20:21], s35
  s_mul_i32 s34, s31, 1152
  s_lshl_b32 s35, s87, 7
  s_add_u32 s34, s34, s35
  buffer_load_ushort v73, v31, s[44:47], s34 offen
  s_mov_b32 s71, 0x3fb8aa3b
  s_mov_b32 s72, 0xbfb8aa3b
  v_lshlrev_b32 v253, 4, v0
  s_mov_b32 s52, s12
  s_and_b32 s53, s13, 0xffff
  s_mov_b32 s54, 4718592
  s_mov_b32 s55, 0x20000
  s_mov_b32 s73, 0xbdd2d3e8
  v_and_b32 v26, 1, v0
  v_cmp_eq_u32 vcc, 1, v26
  v_mov_b32 v26, 0x0c0c0100
  v_mov_b32 v27, 0x01000c0c
  v_cndmask_b32 v26, v26, v27, vcc
  v_mov_b32 v27, 0x0c0c0302
  v_mov_b32 v28, 0x03020c0c
  v_cndmask_b32 v27, v27, v28, vcc
  v_bfe_u32 v28, v0, 1, 2
  v_mov_b32 v29, 0x0c0c0c0c
  v_cmp_eq_u32 vcc, 0, v28
  s_nop 1
  v_cndmask_b32 v5, v29, v26, vcc
  v_cndmask_b32 v9, v29, v27, vcc
  v_cmp_eq_u32 vcc, 1, v28
  s_nop 1
  v_cndmask_b32 v6, v29, v26, vcc
  v_cndmask_b32 v10, v29, v27, vcc
  v_cmp_eq_u32 vcc, 2, v28
  s_nop 1
  v_cndmask_b32 v7, v29, v26, vcc
  v_cndmask_b32 v11, v29, v27, vcc
  v_cmp_eq_u32 vcc, 3, v28
  s_nop 1
  v_cndmask_b32 v8, v29, v26, vcc
  v_cndmask_b32 v12, v29, v27, vcc
  v_and_b32 v26, 0x23, v0
  v_bfe_u32 v27, v0, 2, 2
  v_lshl_add_u32 v26, v27, 3, v26
  v_bfe_u32 v27, v0, 4, 1
  v_lshl_add_u32 v26, v27, 2, v26
  v_lshlrev_b32 v249, 4, v26
  v_mov_b32 v32, -1
  v_mov_b32 v34, -1
  v_mov_b32 v35, -1
  ds_write_b128 v253, v[32:35] offset:12288
  ds_write_b128 v253, v[32:35] offset:13312
  v_add_u32 v36, 33280, v253
  ds_write_b128 v36, v[32:35] offset:0
  ds_write_b128 v36, v[32:35] offset:1024
  ds_write_b128 v36, v[32:35] offset:2048
  ds_write_b128 v36, v[32:35] offset:3072
  ds_write_b128 v36, v[32:35] offset:4096
  ds_write_b128 v36, v[32:35] offset:5120
  ds_write_b128 v36, v[32:35] offset:6144
  ds_write_b128 v36, v[32:35] offset:7168
  ds_write_b128 v36, v[32:35] offset:8192
  ds_write_b128 v36, v[32:35] offset:9216
  ds_write_b128 v36, v[32:35] offset:10240
  ds_write_b128 v36, v[32:35] offset:11264
  ds_write_b128 v36, v[32:35] offset:12288
  ds_write_b128 v36, v[32:35] offset:13312
  ds_write_b128 v36, v[32:35] offset:14336
  ds_write_b128 v36, v[32:35] offset:15360
  ds_write_b128 v36, v[32:35] offset:16384
  ds_write_b128 v36, v[32:35] offset:17408
  ds_write_b128 v36, v[32:35] offset:18432
  ds_write_b128 v36, v[32:35] offset:19456
  ds_write_b128 v36, v[32:35] offset:20480
  ds_write_b128 v36, v[32:35] offset:21504
  ds_write_b128 v36, v[32:35] offset:22528
  ds_write_b128 v36, v[32:35] offset:23552
  ds_write_b128 v36, v[32:35] offset:24576
  ds_write_b128 v36, v[32:35] offset:25600
  ds_write_b128 v36, v[32:35] offset:26624
  ds_write_b128 v36, v[32:35] offset:27648
  ds_write_b128 v36, v[32:35] offset:28672
  ds_write_b128 v36, v[32:35] offset:29696
  ds_write_b128 v36, v[32:35] offset:30720
  ds_write_b128 v36, v[32:35] offset:31744
  s_waitcnt vmcnt(22)
  v_lshlrev_b32 v84, 16, v64
  v_and_b32 v85, 0xffff0000, v64
  v_lshlrev_b32 v86, 16, v65
  v_and_b32 v87, 0xffff0000, v65
  v_lshlrev_b32 v88, 16, v66
  v_and_b32 v89, 0xffff0000, v66
  v_lshlrev_b32 v90, 16, v67
  v_and_b32 v91, 0xffff0000, v67
  v_lshlrev_b32 v92, 16, v68
  v_and_b32 v93, 0xffff0000, v68
  v_lshlrev_b32 v94, 16, v69
  v_and_b32 v95, 0xffff0000, v69
  v_lshlrev_b32 v96, 16, v70
  v_and_b32 v97, 0xffff0000, v70
  v_lshlrev_b32 v98, 16, v71
  v_and_b32 v99, 0xffff0000, v71
  v_lshlrev_b32 v100, 16, v72
  v_and_b32 v101, 0xffff0000, v72
  s_waitcnt lgkmcnt(0)
  v_add_f32 v34, v84, v85
  v_add_f32 v35, v86, v87
  v_add_f32 v34, v34, v88
  v_add_f32 v35, v35, v89
  v_add_f32 v34, v34, v90
  v_add_f32 v35, v35, v91
  v_add_f32 v34, v34, v92
  v_add_f32 v35, v35, v93
  v_add_f32 v34, v34, v94
  v_add_f32 v35, v35, v95
  v_add_f32 v34, v34, v96
  v_add_f32 v35, v35, v97
  v_add_f32 v34, v34, v98
  v_add_f32 v35, v35, v99
  v_add_f32 v34, v34, v100
  v_add_f32 v35, v35, v101
  v_add_f32 v34, v34, v35
  s_nop 1
  v_add_f32_dpp v34, v34, v34 quad_perm:[1,0,3,2] row_mask:0xf bank_mask:0xf
  s_nop 1
  v_add_f32_dpp v34, v34, v34 quad_perm:[2,3,0,1] row_mask:0xf bank_mask:0xf
  s_nop 1
  v_add_f32_dpp v34, v34, v34 row_half_mirror row_mask:0xf bank_mask:0xf
  v_mov_b32 v35, v34
  s_nop 1
  v_permlane16_swap_b32 v35, v34
  v_add_f32 v34, v34, v35
  v_mov_b32 v35, v34
  s_nop 1
  v_permlane32_swap_b32 v35, v34
  v_add_f32 v34, v34, v35
  v_mul_f32 v32, 0x3ae38e39, v34
  v_sub_f32 v36, v84, v32
  v_mul_f32 v34, v36, v36
  v_sub_f32 v35, v85, v32
  v_fmac_f32 v34, v35, v35
  v_sub_f32 v36, v86, v32
  v_fmac_f32 v34, v36, v36
  v_sub_f32 v35, v87, v32
  v_fmac_f32 v34, v35, v35
  v_sub_f32 v36, v88, v32
  v_fmac_f32 v34, v36, v36
  v_sub_f32 v35, v89, v32
  v_fmac_f32 v34, v35, v35
  v_sub_f32 v36, v90, v32
  v_fmac_f32 v34, v36, v36
  v_sub_f32 v35, v91, v32
  v_fmac_f32 v34, v35, v35
  v_sub_f32 v36, v92, v32
  v_fmac_f32 v34, v36, v36
  v_sub_f32 v35, v93, v32
  v_fmac_f32 v34, v35, v35
  v_sub_f32 v36, v94, v32
  v_fmac_f32 v34, v36, v36
  v_sub_f32 v35, v95, v32
  v_fmac_f32 v34, v35, v35
  v_sub_f32 v36, v96, v32
  v_fmac_f32 v34, v36, v36
  v_sub_f32 v35, v97, v32
  v_fmac_f32 v34, v35, v35
  v_sub_f32 v36, v98, v32
  v_fmac_f32 v34, v36, v36
  v_sub_f32 v35, v99, v32
  v_fmac_f32 v34, v35, v35
  v_sub_f32 v36, v100, v32
  v_fmac_f32 v34, v36, v36
  v_sub_f32 v35, v101, v32
  v_fmac_f32 v34, v35, v35
  s_nop 1
  v_add_f32_dpp v34, v34, v34 quad_perm:[1,0,3,2] row_mask:0xf bank_mask:0xf
  s_nop 1
  v_add_f32_dpp v34, v34, v34 quad_perm:[2,3,0,1] row_mask:0xf bank_mask:0xf
  s_nop 1
  v_add_f32_dpp v34, v34, v34 row_half_mirror row_mask:0xf bank_mask:0xf
  v_mov_b32 v35, v34
  s_nop 1
  v_permlane16_swap_b32 v35, v34
  v_add_f32 v34, v34, v35
  v_mov_b32 v35, v34
  s_nop 1
  v_permlane32_swap_b32 v35, v34
  v_add_f32 v34, v34, v35
  v_mul_f32 v34, 0x3ae38e39, v34
  v_cvt_pk_bf16_f32 v34, v34, v34
  v_and_b32 v34, 0xffff0000, v34
  v_add_f32 v34, 0x3727c5ac, v34
  v_cvt_pk_bf16_f32 v34, v34, v34
  v_and_b32 v34, 0xffff0000, v34
  v_sqrt_f32 v34, v34
  s_nop 0
  v_cvt_pk_bf16_f32 v34, v34, v34
  v_and_b32 v34, 0xffff0000, v34
  v_rcp_f32 v33, v34
  v_cvt_pk_bf16_f32 v32, v32, v32
  v_and_b32 v32, 0xffff0000, v32
  s_waitcnt vmcnt(19)
  s_mul_i32 s76, s76, 1664525
  s_add_u32 s76, s76, 1013904223
  s_mul_i32 s78, s78, 0x9e3779b4
  s_add_u32 s76, s76, s78
  v_mov_b32 v254, s76
  v_lshlrev_b32 v34, 16, v74
  v_and_b32 v35, 0xffff0000, v74
  v_sub_f32 v34, v34, v32
  v_sub_f32 v35, v35, v32
  v_cvt_pk_bf16_f32 v34, v34, v35
  v_and_b32 v35, 0xffff0000, v34
  v_lshlrev_b32 v34, 16, v34
  v_mul_f32 v34, v34, v33
  v_mul_f32 v35, v35, v33
  v_cvt_pk_bf16_f32 v74, v34, v35
  v_perm_b32 v24, v74, v74, v5
  v_perm_b32 v25, v74, v74, v6
  v_perm_b32 v26, v74, v74, v7
  v_perm_b32 v27, v74, v74, v8
  v_perm_b32 v28, v74, v74, v9
  v_perm_b32 v29, v74, v74, v10
  v_perm_b32 v30, v74, v74, v11
  v_perm_b32 v31, v74, v74, v12
  s_waitcnt vmcnt(17)
  s_nop 0
  v_mfma_f32_16x16x32_bf16 v[16:19], v[24:27], v[104:107], 0
  v_mfma_f32_16x16x32_bf16 v[16:19], v[28:31], v[108:111], v[16:19]
  v_lshlrev_b32 v34, 16, v75
  v_and_b32 v35, 0xffff0000, v75
  v_sub_f32 v34, v34, v32
  v_sub_f32 v35, v35, v32
  v_cvt_pk_bf16_f32 v34, v34, v35
  v_and_b32 v35, 0xffff0000, v34
  v_lshlrev_b32 v34, 16, v34
  v_mul_f32 v34, v34, v33
  v_mul_f32 v35, v35, v33
  v_cvt_pk_bf16_f32 v75, v34, v35
  v_perm_b32 v24, v75, v75, v5
  v_perm_b32 v25, v75, v75, v6
  v_perm_b32 v26, v75, v75, v7
  v_perm_b32 v27, v75, v75, v8
  v_perm_b32 v28, v75, v75, v9
  v_perm_b32 v29, v75, v75, v10
  v_perm_b32 v30, v75, v75, v11
  v_perm_b32 v31, v75, v75, v12
  s_waitcnt vmcnt(15)
  s_nop 0
  v_mfma_f32_16x16x32_bf16 v[16:19], v[24:27], v[112:115], v[16:19]
  v_mfma_f32_16x16x32_bf16 v[16:19], v[28:31], v[116:119], v[16:19]
  v_lshlrev_b32 v34, 16, v76
  v_and_b32 v35, 0xffff0000, v76
  v_sub_f32 v34, v34, v32
  v_sub_f32 v35, v35, v32
  v_cvt_pk_bf16_f32 v34, v34, v35
  v_and_b32 v35, 0xffff0000, v34
  v_lshlrev_b32 v34, 16, v34
  v_mul_f32 v34, v34, v33
  v_mul_f32 v35, v35, v33
  v_cvt_pk_bf16_f32 v76, v34, v35
  v_perm_b32 v24, v76, v76, v5
  v_perm_b32 v25, v76, v76, v6
  v_perm_b32 v26, v76, v76, v7
  v_perm_b32 v27, v76, v76, v8
  v_perm_b32 v28, v76, v76, v9
  v_perm_b32 v29, v76, v76, v10
  v_perm_b32 v30, v76, v76, v11
  v_perm_b32 v31, v76, v76, v12
  s_waitcnt vmcnt(13)
  s_nop 0
  v_mfma_f32_16x16x32_bf16 v[16:19], v[24:27], v[120:123], v[16:19]
  v_mfma_f32_16x16x32_bf16 v[16:19], v[28:31], v[124:127], v[16:19]
  v_lshlrev_b32 v34, 16, v77
  v_and_b32 v35, 0xffff0000, v77
  v_sub_f32 v34, v34, v32
  v_sub_f32 v35, v35, v32
  v_cvt_pk_bf16_f32 v34, v34, v35
  v_and_b32 v35, 0xffff0000, v34
  v_lshlrev_b32 v34, 16, v34
  v_mul_f32 v34, v34, v33
  v_mul_f32 v35, v35, v33
  v_cvt_pk_bf16_f32 v77, v34, v35
  v_perm_b32 v24, v77, v77, v5
  v_perm_b32 v25, v77, v77, v6
  v_perm_b32 v26, v77, v77, v7
  v_perm_b32 v27, v77, v77, v8
  v_perm_b32 v28, v77, v77, v9
  v_perm_b32 v29, v77, v77, v10
  v_perm_b32 v30, v77, v77, v11
  v_perm_b32 v31, v77, v77, v12
  s_waitcnt vmcnt(11)
  s_nop 0
  v_mfma_f32_16x16x32_bf16 v[16:19], v[24:27], v[128:131], v[16:19]
  v_mfma_f32_16x16x32_bf16 v[16:19], v[28:31], v[132:135], v[16:19]
  v_lshlrev_b32 v34, 16, v78
  v_and_b32 v35, 0xffff0000, v78
  v_sub_f32 v34, v34, v32
  v_sub_f32 v35, v35, v32
  v_cvt_pk_bf16_f32 v34, v34, v35
  v_and_b32 v35, 0xffff0000, v34
  v_lshlrev_b32 v34, 16, v34
  v_mul_f32 v34, v34, v33
  v_mul_f32 v35, v35, v33
  v_cvt_pk_bf16_f32 v78, v34, v35
  v_perm_b32 v24, v78, v78, v5
  v_perm_b32 v25, v78, v78, v6
  v_perm_b32 v26, v78, v78, v7
  v_perm_b32 v27, v78, v78, v8
  v_perm_b32 v28, v78, v78, v9
  v_perm_b32 v29, v78, v78, v10
  v_perm_b32 v30, v78, v78, v11
  v_perm_b32 v31, v78, v78, v12
  s_waitcnt vmcnt(9)
  s_nop 0
  v_mfma_f32_16x16x32_bf16 v[16:19], v[24:27], v[136:139], v[16:19]
  v_mfma_f32_16x16x32_bf16 v[16:19], v[28:31], v[140:143], v[16:19]
  v_lshlrev_b32 v34, 16, v79
  v_and_b32 v35, 0xffff0000, v79
  v_sub_f32 v34, v34, v32
  v_sub_f32 v35, v35, v32
  v_cvt_pk_bf16_f32 v34, v34, v35
  v_and_b32 v35, 0xffff0000, v34
  v_lshlrev_b32 v34, 16, v34
  v_mul_f32 v34, v34, v33
  v_mul_f32 v35, v35, v33
  v_cvt_pk_bf16_f32 v79, v34, v35
  v_perm_b32 v24, v79, v79, v5
  v_perm_b32 v25, v79, v79, v6
  v_perm_b32 v26, v79, v79, v7
  v_perm_b32 v27, v79, v79, v8
  v_perm_b32 v28, v79, v79, v9
  v_perm_b32 v29, v79, v79, v10
  v_perm_b32 v30, v79, v79, v11
  v_perm_b32 v31, v79, v79, v12
  s_waitcnt vmcnt(7)
  s_nop 0
  v_mfma_f32_16x16x32_bf16 v[16:19], v[24:27], v[144:147], v[16:19]
  v_mfma_f32_16x16x32_bf16 v[16:19], v[28:31], v[148:151], v[16:19]
  v_lshlrev_b32 v34, 16, v80
  v_and_b32 v35, 0xffff0000, v80
  v_sub_f32 v34, v34, v32
  v_sub_f32 v35, v35, v32
  v_cvt_pk_bf16_f32 v34, v34, v35
  v_and_b32 v35, 0xffff0000, v34
  v_lshlrev_b32 v34, 16, v34
  v_mul_f32 v34, v34, v33
  v_mul_f32 v35, v35, v33
  v_cvt_pk_bf16_f32 v80, v34, v35
  v_perm_b32 v24, v80, v80, v5
  v_perm_b32 v25, v80, v80, v6
  v_perm_b32 v26, v80, v80, v7
  v_perm_b32 v27, v80, v80, v8
  v_perm_b32 v28, v80, v80, v9
  v_perm_b32 v29, v80, v80, v10
  v_perm_b32 v30, v80, v80, v11
  v_perm_b32 v31, v80, v80, v12
  s_waitcnt vmcnt(5)
  s_nop 0
  v_mfma_f32_16x16x32_bf16 v[16:19], v[24:27], v[152:155], v[16:19]
  v_mfma_f32_16x16x32_bf16 v[16:19], v[28:31], v[156:159], v[16:19]
  v_lshlrev_b32 v34, 16, v81
  v_and_b32 v35, 0xffff0000, v81
  v_sub_f32 v34, v34, v32
  v_sub_f32 v35, v35, v32
  v_cvt_pk_bf16_f32 v34, v34, v35
  v_and_b32 v35, 0xffff0000, v34
  v_lshlrev_b32 v34, 16, v34
  v_mul_f32 v34, v34, v33
  v_mul_f32 v35, v35, v33
  v_cvt_pk_bf16_f32 v81, v34, v35
  v_perm_b32 v24, v81, v81, v5
  v_perm_b32 v25, v81, v81, v6
  v_perm_b32 v26, v81, v81, v7
  v_perm_b32 v27, v81, v81, v8
  v_perm_b32 v28, v81, v81, v9
  v_perm_b32 v29, v81, v81, v10
  v_perm_b32 v30, v81, v81, v11
  v_perm_b32 v31, v81, v81, v12
  s_waitcnt vmcnt(3)
  s_nop 0
  v_mfma_f32_16x16x32_bf16 v[16:19], v[24:27], v[160:163], v[16:19]
  v_mfma_f32_16x16x32_bf16 v[16:19], v[28:31], v[164:167], v[16:19]
  v_lshlrev_b32 v34, 16, v82
  v_and_b32 v35, 0xffff0000, v82
  v_sub_f32 v34, v34, v32
  v_sub_f32 v35, v35, v32
  v_cvt_pk_bf16_f32 v34, v34, v35
  v_and_b32 v35, 0xffff0000, v34
  v_lshlrev_b32 v34, 16, v34
  v_mul_f32 v34, v34, v33
  v_mul_f32 v35, v35, v33
  v_cvt_pk_bf16_f32 v82, v34, v35
  v_perm_b32 v24, v82, v82, v5
  v_perm_b32 v25, v82, v82, v6
  v_perm_b32 v26, v82, v82, v7
  v_perm_b32 v27, v82, v82, v8
  v_perm_b32 v28, v82, v82, v9
  v_perm_b32 v29, v82, v82, v10
  v_perm_b32 v30, v82, v82, v11
  v_perm_b32 v31, v82, v82, v12
  s_waitcnt vmcnt(1)
  s_nop 0
  v_mfma_f32_16x16x32_bf16 v[16:19], v[24:27], v[168:171], v[16:19]
  v_mfma_f32_16x16x32_bf16 v[16:19], v[28:31], v[172:175], v[16:19]
  s_nop 5
  s_lshl_b32 s34, s30, 4
  s_add_u32 s35, s34, s82
  s_lshl_b32 s35, s35, 11
  s_add_u32 s35, s35, 4096
  v_mov_b32 v21, s76
  v_mov_b32 v23, s76
  v_mov_b32 v22, v19
  v_mov_b32 v20, v18
  v_mov_b32 v18, v17
  v_mov_b32 v17, s76
  v_mov_b32 v19, s76
  buffer_store_dwordx4 v[16:19], v249, s[56:59], s35 offen sc1
  buffer_store_dwordx4 v[20:23], v249, s[56:59], s35 offen offset:1024 sc1
  s_lshl_b32 s83, s31, 3
  v_readlane_b32 s88, v32, s83
  v_readlane_b32 s89, v33, s83
  v_sub_f32 v84, v84, v32
  v_sub_f32 v85, v85, v32
  v_cvt_pk_bf16_f32 v84, v84, v85
  v_and_b32 v85, 0xffff0000, v84
  v_lshlrev_b32 v84, 16, v84
  v_mul_f32 v84, v84, v33
  v_mul_f32 v85, v85, v33
  v_cvt_pk_bf16_f32 v34, v84, v85
  v_lshlrev_b32 v84, 16, v34
  v_and_b32 v85, 0xffff0000, v34
  v_sub_f32 v86, v86, v32
  v_sub_f32 v87, v87, v32
  v_cvt_pk_bf16_f32 v86, v86, v87
  v_and_b32 v87, 0xffff0000, v86
  v_lshlrev_b32 v86, 16, v86
  v_mul_f32 v86, v86, v33
  v_mul_f32 v87, v87, v33
  v_cvt_pk_bf16_f32 v34, v86, v87
  v_lshlrev_b32 v86, 16, v34
  v_and_b32 v87, 0xffff0000, v34
  v_sub_f32 v88, v88, v32
  v_sub_f32 v89, v89, v32
  v_cvt_pk_bf16_f32 v88, v88, v89
  v_and_b32 v89, 0xffff0000, v88
  v_lshlrev_b32 v88, 16, v88
  v_mul_f32 v88, v88, v33
  v_mul_f32 v89, v89, v33
  v_cvt_pk_bf16_f32 v34, v88, v89
  v_lshlrev_b32 v88, 16, v34
  v_and_b32 v89, 0xffff0000, v34
  v_sub_f32 v90, v90, v32
  v_sub_f32 v91, v91, v32
  v_cvt_pk_bf16_f32 v90, v90, v91
  v_and_b32 v91, 0xffff0000, v90
  v_lshlrev_b32 v90, 16, v90
  v_mul_f32 v90, v90, v33
  v_mul_f32 v91, v91, v33
  v_cvt_pk_bf16_f32 v34, v90, v91
  v_lshlrev_b32 v90, 16, v34
  v_and_b32 v91, 0xffff0000, v34
  v_sub_f32 v92, v92, v32
  v_sub_f32 v93, v93, v32
  v_cvt_pk_bf16_f32 v92, v92, v93
  v_and_b32 v93, 0xffff0000, v92
  v_lshlrev_b32 v92, 16, v92
  v_mul_f32 v92, v92, v33
  v_mul_f32 v93, v93, v33
  v_cvt_pk_bf16_f32 v34, v92, v93
  v_lshlrev_b32 v92, 16, v34
  v_and_b32 v93, 0xffff0000, v34
  v_sub_f32 v94, v94, v32
  v_sub_f32 v95, v95, v32
  v_cvt_pk_bf16_f32 v94, v94, v95
  v_and_b32 v95, 0xffff0000, v94
  v_lshlrev_b32 v94, 16, v94
  v_mul_f32 v94, v94, v33
  v_mul_f32 v95, v95, v33
  v_cvt_pk_bf16_f32 v34, v94, v95
  v_lshlrev_b32 v94, 16, v34
  v_and_b32 v95, 0xffff0000, v34
  v_sub_f32 v96, v96, v32
  v_sub_f32 v97, v97, v32
  v_cvt_pk_bf16_f32 v96, v96, v97
  v_and_b32 v97, 0xffff0000, v96
  v_lshlrev_b32 v96, 16, v96
  v_mul_f32 v96, v96, v33
  v_mul_f32 v97, v97, v33
  v_cvt_pk_bf16_f32 v34, v96, v97
  v_lshlrev_b32 v96, 16, v34
  v_and_b32 v97, 0xffff0000, v34
  v_sub_f32 v98, v98, v32
  v_sub_f32 v99, v99, v32
  v_cvt_pk_bf16_f32 v98, v98, v99
  v_and_b32 v99, 0xffff0000, v98
  v_lshlrev_b32 v98, 16, v98
  v_mul_f32 v98, v98, v33
  v_mul_f32 v99, v99, v33
  v_cvt_pk_bf16_f32 v34, v98, v99
  v_lshlrev_b32 v98, 16, v34
  v_and_b32 v99, 0xffff0000, v34
  v_sub_f32 v100, v100, v32
  v_sub_f32 v101, v101, v32
  v_cvt_pk_bf16_f32 v100, v100, v101
  v_and_b32 v101, 0xffff0000, v100
  v_lshlrev_b32 v100, 16, v100
  v_mul_f32 v100, v100, v33
  v_mul_f32 v101, v101, v33
  v_cvt_pk_bf16_f32 v34, v100, v101
  v_lshlrev_b32 v100, 16, v34
  v_and_b32 v101, 0xffff0000, v34
  v_add_f32 v34, v84, v85
  v_add_f32 v35, v86, v87
  v_add_f32 v34, v34, v88
  v_add_f32 v35, v35, v89
  v_add_f32 v34, v34, v90
  v_add_f32 v35, v35, v91
  v_add_f32 v34, v34, v92
  v_add_f32 v35, v35, v93
  v_add_f32 v34, v34, v94
  v_add_f32 v35, v35, v95
  v_add_f32 v34, v34, v96
  v_add_f32 v35, v35, v97
  v_add_f32 v34, v34, v98
  v_add_f32 v35, v35, v99
  v_add_f32 v34, v34, v100
  v_add_f32 v35, v35, v101
  v_add_f32 v34, v34, v35
  s_nop 1
  v_add_f32_dpp v34, v34, v34 quad_perm:[1,0,3,2] row_mask:0xf bank_mask:0xf
  s_nop 1
  v_add_f32_dpp v34, v34, v34 quad_perm:[2,3,0,1] row_mask:0xf bank_mask:0xf
  s_nop 1
  v_add_f32_dpp v34, v34, v34 row_half_mirror row_mask:0xf bank_mask:0xf
  v_mov_b32 v35, v34
  s_nop 1
  v_permlane16_swap_b32 v35, v34
  v_add_f32 v34, v34, v35
  v_mov_b32 v35, v34
  s_nop 1
  v_permlane32_swap_b32 v35, v34
  v_add_f32 v34, v34, v35
  v_mul_f32 v32, 0x3ae38e39, v34
  v_sub_f32 v36, v84, v32
  v_mul_f32 v34, v36, v36
  v_sub_f32 v35, v85, v32
  v_fmac_f32 v34, v35, v35
  v_sub_f32 v36, v86, v32
  v_fmac_f32 v34, v36, v36
  v_sub_f32 v35, v87, v32
  v_fmac_f32 v34, v35, v35
  v_sub_f32 v36, v88, v32
  v_fmac_f32 v34, v36, v36
  v_sub_f32 v35, v89, v32
  v_fmac_f32 v34, v35, v35
  v_sub_f32 v36, v90, v32
  v_fmac_f32 v34, v36, v36
  v_sub_f32 v35, v91, v32
  v_fmac_f32 v34, v35, v35
  v_sub_f32 v36, v92, v32
  v_fmac_f32 v34, v36, v36
  v_sub_f32 v35, v93, v32
  v_fmac_f32 v34, v35, v35
  v_sub_f32 v36, v94, v32
  v_fmac_f32 v34, v36, v36
  v_sub_f32 v35, v95, v32
  v_fmac_f32 v34, v35, v35
  v_sub_f32 v36, v96, v32
  v_fmac_f32 v34, v36, v36
  v_sub_f32 v35, v97, v32
  v_fmac_f32 v34, v35, v35
  v_sub_f32 v36, v98, v32
  v_fmac_f32 v34, v36, v36
  v_sub_f32 v35, v99, v32
  v_fmac_f32 v34, v35, v35
  v_sub_f32 v36, v100, v32
  v_fmac_f32 v34, v36, v36
  v_sub_f32 v35, v101, v32
  v_fmac_f32 v34, v35, v35
  s_nop 1
  v_add_f32_dpp v34, v34, v34 quad_perm:[1,0,3,2] row_mask:0xf bank_mask:0xf
  s_nop 1
  v_add_f32_dpp v34, v34, v34 quad_perm:[2,3,0,1] row_mask:0xf bank_mask:0xf
  s_nop 1
  v_add_f32_dpp v34, v34, v34 row_half_mirror row_mask:0xf bank_mask:0xf
  v_mov_b32 v35, v34
  s_nop 1
  v_permlane16_swap_b32 v35, v34
  v_add_f32 v34, v34, v35
  v_mov_b32 v35, v34
  s_nop 1
  v_permlane32_swap_b32 v35, v34
  v_add_f32 v34, v34, v35
  v_mul_f32 v34, 0x3ae38e39, v34
  v_cvt_pk_bf16_f32 v34, v34, v34
  v_and_b32 v34, 0xffff0000, v34
  v_add_f32 v34, 0x3727c5ac, v34
  v_cvt_pk_bf16_f32 v34, v34, v34
  v_and_b32 v34, 0xffff0000, v34
  v_sqrt_f32 v34, v34
  s_nop 0
  v_cvt_pk_bf16_f32 v34, v34, v34
  v_and_b32 v34, 0xffff0000, v34
  v_rcp_f32 v33, v34
  v_cvt_pk_bf16_f32 v32, v32, v32
  v_and_b32 v32, 0xffff0000, v32
  s_waitcnt vmcnt(2)
  v_lshlrev_b32 v37, 16, v73
  v_subrev_f32 v37, s88, v37
  v_cvt_pk_bf16_f32 v37, v37, v37
  v_and_b32 v37, 0xffff0000, v37
  v_mul_f32 v37, s89, v37
  v_cvt_pk_bf16_f32 v37, v37, v37
  v_and_b32 v37, 0xffff0000, v37
  v_readlane_b32 s88, v32, s83
  v_readlane_b32 s89, v33, s83
  s_nop 1
  v_subrev_f32 v37, s88, v37
  v_cvt_pk_bf16_f32 v37, v37, v37
  v_and_b32 v37, 0xffff0000, v37
  v_mul_f32 v37, s89, v37
  v_cvt_pk_bf16_f32 v37, v37, v37
  v_and_b32 v37, 0xffff0000, v37
  v_mov_b32 v39, 0
  v_mov_b32 v40, 0xc0135761
  s_mul_i32 s36, s86, 768
  s_mov_b32 s39, 0
  s_mov_b32 s40, 0
  s_branch L_q2
L_bloop:
  s_load_dwordx4 s[80:83], s[16:17], s36
  s_load_dwordx4 s[84:87], s[18:19], s36
  s_load_dwordx4 s[88:91], s[20:21], s36
  s_waitcnt lgkmcnt(0)
  s_lshl_b32 s64, s80, 16
  s_and_b32 s65, s80, 0xffff0000
  s_lshl_b32 s66, s84, 16
  s_and_b32 s67, s84, 0xffff0000
  s_lshl_b32 s68, s88, 16
  s_and_b32 s69, s88, 0xffff0000
  v_mul_f32 v42, s64, v37
  v_mul_f32 v43, s65, v37
  v_cvt_pk_bf16_f32 v46, v42, v43
  v_lshlrev_b32 v42, 16, v46
  v_and_b32 v43, 0xffff0000, v46
  v_add_f32 v42, s66, v42
  v_add_f32 v43, s67, v43
  v_cvt_pk_bf16_f32 v46, v42, v43
  v_lshlrev_b32 v42, 16, v46
  v_and_b32 v43, 0xffff0000, v46
  v_mul_f32 v44, v42, v42
  v_mul_f32 v45, v43, v43
  v_fma_f32 v44, v44, s73, v40
  v_fma_f32 v45, v45, s73, v40
  v_mul_f32 v44, v44, v42
  v_mul_f32 v45, v45, v43
  v_exp_f32 v44, v44
  v_exp_f32 v45, v45
  v_add_f32 v44, 1.0, v44
  v_add_f32 v45, 1.0, v45
  v_rcp_f32 v44, v44
  v_rcp_f32 v45, v45
  v_mul_f32 v44, v44, v42
  v_mul_f32 v45, v45, v43
  v_cvt_pk_bf16_f32 v46, v44, v45
  v_lshlrev_b32 v42, 16, v46
  v_and_b32 v43, 0xffff0000, v46
  v_fmac_f32 v39, s68, v42
  v_fmac_f32 v39, s69, v43
  s_lshl_b32 s64, s81, 16
  s_and_b32 s65, s81, 0xffff0000
  s_lshl_b32 s66, s85, 16
  s_and_b32 s67, s85, 0xffff0000
  s_lshl_b32 s68, s89, 16
  s_and_b32 s69, s89, 0xffff0000
  v_mul_f32 v42, s64, v37
  v_mul_f32 v43, s65, v37
  v_cvt_pk_bf16_f32 v46, v42, v43
  v_lshlrev_b32 v42, 16, v46
  v_and_b32 v43, 0xffff0000, v46
  v_add_f32 v42, s66, v42
  v_add_f32 v43, s67, v43
  v_cvt_pk_bf16_f32 v46, v42, v43
  v_lshlrev_b32 v42, 16, v46
  v_and_b32 v43, 0xffff0000, v46
  v_mul_f32 v44, v42, v42
  v_mul_f32 v45, v43, v43
  v_fma_f32 v44, v44, s73, v40
  v_fma_f32 v45, v45, s73, v40
  v_mul_f32 v44, v44, v42
  v_mul_f32 v45, v45, v43
  v_exp_f32 v44, v44
  v_exp_f32 v45, v45
  v_add_f32 v44, 1.0, v44
  v_add_f32 v45, 1.0, v45
  v_rcp_f32 v44, v44
  v_rcp_f32 v45, v45
  v_mul_f32 v44, v44, v42
  v_mul_f32 v45, v45, v43
  v_cvt_pk_bf16_f32 v46, v44, v45
  v_lshlrev_b32 v42, 16, v46
  v_and_b32 v43, 0xffff0000, v46
  v_fmac_f32 v39, s68, v42
  v_fmac_f32 v39, s69, v43
  s_lshl_b32 s64, s82, 16
  s_and_b32 s65, s82, 0xffff0000
  s_lshl_b32 s66, s86, 16
  s_and_b32 s67, s86, 0xffff0000
  s_lshl_b32 s68, s90, 16
  s_and_b32 s69, s90, 0xffff0000
  v_mul_f32 v42, s64, v37
  v_mul_f32 v43, s65, v37
  v_cvt_pk_bf16_f32 v46, v42, v43
  v_lshlrev_b32 v42, 16, v46
  v_and_b32 v43, 0xffff0000, v46
  v_add_f32 v42, s66, v42
  v_add_f32 v43, s67, v43
  v_cvt_pk_bf16_f32 v46, v42, v43
  v_lshlrev_b32 v42, 16, v46
  v_and_b32 v43, 0xffff0000, v46
  v_mul_f32 v44, v42, v42
  v_mul_f32 v45, v43, v43
  v_fma_f32 v44, v44, s73, v40
  v_fma_f32 v45, v45, s73, v40
  v_mul_f32 v44, v44, v42
  v_mul_f32 v45, v45, v43
  v_exp_f32 v44, v44
  v_exp_f32 v45, v45
  v_add_f32 v44, 1.0, v44
  v_add_f32 v45, 1.0, v45
  v_rcp_f32 v44, v44
  v_rcp_f32 v45, v45
  v_mul_f32 v44, v44, v42
  v_mul_f32 v45, v45, v43
  v_cvt_pk_bf16_f32 v46, v44, v45
  v_lshlrev_b32 v42, 16, v46
  v_and_b32 v43, 0xffff0000, v46
  v_fmac_f32 v39, s68, v42
  v_fmac_f32 v39, s69, v43
  s_lshl_b32 s64, s83, 16
  s_and_b32 s65, s83, 0xffff0000
  s_lshl_b32 s66, s87, 16
  s_and_b32 s67, s87, 0xffff0000
  s_lshl_b32 s68, s91, 16
  s_and_b32 s69, s91, 0xffff0000
  v_mul_f32 v42, s64, v37
  v_mul_f32 v43, s65, v37
  v_cvt_pk_bf16_f32 v46, v42, v43
  v_lshlrev_b32 v42, 16, v46
  v_and_b32 v43, 0xffff0000, v46
  v_add_f32 v42, s66, v42
  v_add_f32 v43, s67, v43
  v_cvt_pk_bf16_f32 v46, v42, v43
  v_lshlrev_b32 v42, 16, v46
  v_and_b32 v43, 0xffff0000, v46
  v_mul_f32 v44, v42, v42
  v_mul_f32 v45, v43, v43
  v_fma_f32 v44, v44, s73, v40
  v_fma_f32 v45, v45, s73, v40
  v_mul_f32 v44, v44, v42
  v_mul_f32 v45, v45, v43
  v_exp_f32 v44, v44
  v_exp_f32 v45, v45
  v_add_f32 v44, 1.0, v44
  v_add_f32 v45, 1.0, v45
  v_rcp_f32 v44, v44
  v_rcp_f32 v45, v45
  v_mul_f32 v44, v44, v42
  v_mul_f32 v45, v45, v43
  v_cvt_pk_bf16_f32 v46, v44, v45
  v_lshlrev_b32 v42, 16, v46
  v_and_b32 v43, 0xffff0000, v46
  v_fmac_f32 v39, s68, v42
  v_fmac_f32 v39, s69, v43
  s_add_u32 s36, s36, 16
  s_add_u32 s39, s39, 1
  s_cmp_lt_u32 s39, s40
  s_cbranch_scc1 L_bloop
  s_cmp_eq_u32 s40, 48
  s_cbranch_scc1 L_bdone
  s_cmp_eq_u32 s40, 2
  s_cbranch_scc1 L_q3
L_q2:
  v_lshrrev_b32 v34, 3, v0
  v_lshlrev_b32 v34, 12, v34
  v_and_b32 v35, 7, v0
  v_lshl_add_u32 v34, v35, 4, v34
  s_lshl_b32 s34, s30, 15
  s_lshr_b32 s35, s32, 2
  s_lshl_b32 s35, s35, 11
  s_add_u32 s34, s34, s35
  s_lshl_b32 s35, s31, 9
  s_add_u32 s34, s34, s35
  s_and_b32 s35, s32, 3
  s_lshl_b32 s35, s35, 7
  s_add_u32 s34, s34, s35
  s_add_u32 s34, s34, 4096
  s_mov_b32 s78, 0
L_pollq:
  buffer_load_dwordx4 v[176:179], v34, s[56:59], s34 offen sc1
  buffer_load_dwordx4 v[180:183], v34, s[56:59], s34 offen offset:1024 sc1
  s_waitcnt vmcnt(0)
  v_max_u32 v35, v177, v179
  v_min_u32 v36, v177, v179
  v_max3_u32 v35, v35, v181, v183
  v_min3_u32 v36, v36, v181, v183
  v_xor_b32 v35, v35, v254
  v_xor_b32 v36, v36, v254
  v_or_b32 v35, v35, v36
  v_cmp_ne_u32 vcc, 0, v35
  s_cbranch_vccz L_gotq
  s_sleep 3
  s_add_u32 s78, s78, 1
  s_cmp_lt_u32 s78, 0x40000
  s_cbranch_scc1 L_pollq
L_gotq:
  s_nop 1
  v_add_f32_dpp v176, v176, v176 row_ror:8 row_mask:0xf bank_mask:0xf
  v_add_f32_dpp v178, v178, v178 row_ror:8 row_mask:0xf bank_mask:0xf
  v_add_f32_dpp v180, v180, v180 row_ror:8 row_mask:0xf bank_mask:0xf
  v_add_f32_dpp v182, v182, v182 row_ror:8 row_mask:0xf bank_mask:0xf
  v_mov_b32 v177, v176
  v_mov_b32 v179, v178
  v_mov_b32 v181, v180
  v_mov_b32 v183, v182
  s_nop 1
  v_permlane16_swap_b32 v177, v176
  v_permlane16_swap_b32 v179, v178
  v_permlane16_swap_b32 v181, v180
  v_permlane16_swap_b32 v183, v182
  v_add_f32 v176, v176, v177
  v_add_f32 v178, v178, v179
  v_add_f32 v180, v180, v181
  v_add_f32 v182, v182, v183
  v_mov_b32 v177, v176
  v_mov_b32 v179, v178
  v_mov_b32 v181, v180
  v_mov_b32 v183, v182
  s_nop 1
  v_permlane32_swap_b32 v177, v176
  v_permlane32_swap_b32 v179, v178
  v_permlane32_swap_b32 v181, v180
  v_permlane32_swap_b32 v183, v182
  v_add_f32 v176, v176, v177
  v_add_f32 v178, v178, v179
  v_add_f32 v180, v180, v181
  v_add_f32 v182, v182, v183
  v_cvt_pk_bf16_f32 v16, v176, v178
  v_cvt_pk_bf16_f32 v18, v180, v182
  v_mov_b32 v17, v254
  v_mov_b32 v19, v254
  s_lshl_b32 s34, s2, 7
  s_add_u32 s34, s34, 528384
  s_mov_b64 exec, 0xff
  buffer_store_dwordx4 v[16:19], v253, s[56:59], s34 offen sc1
  s_mov_b64 exec, -1
  s_mov_b32 s40, 2
  s_branch L_bloop
L_q3:
  s_and_b32 s34, s2, 0xf8
  s_lshl_b32 s34, s34, 7
  s_add_u32 s34, s34, 528384
  s_mov_b32 s78, 0
  v_lshrrev_b32 v34, 3, v0
  v_lshlrev_b32 v34, 6, v34
  v_and_b32 v35, 3, v0
  v_lshl_add_u32 v34, v35, 4, v34
  v_bfe_u32 v35, v0, 2, 1
  v_lshl_add_u32 v34, v35, 3, v34
L_pollq3:
  buffer_load_dwordx4 v[176:179], v253, s[56:59], s34 offen sc1
  s_waitcnt vmcnt(0)
  v_max_u32 v35, v177, v179
  v_min_u32 v36, v177, v179
  v_xor_b32 v35, v35, v254
  v_xor_b32 v36, v36, v254
  v_or_b32 v35, v35, v36
  v_cmp_ne_u32 vcc, 0, v35
  s_cbranch_vccz L_gotq3
  s_sleep 3
  s_add_u32 s78, s78, 1
  s_cmp_lt_u32 s78, 0x40000
  s_cbranch_scc1 L_pollq3
L_gotq3:
  v_mov_b32 v177, v178
  ds_write_b64 v34, v[176:177] offset:0
  v_mov_b32 v35, 1
  ds_write_b32 v252, v254 offset:28
  s_waitcnt lgkmcnt(0)
  ds_write_b32 v252, v35 offset:8
  s_setprio 0
  s_mov_b32 s40, 48
  s_branch L_bloop
L_bdone:
  s_lshl_b32 s35, s2, 13
  s_add_u32 s35, s35, 2102272
  s_cmp_ge_u32 s77, 108
  s_cbranch_scc1 L_nobst
  v_mov_b32 v42, v39
  v_mov_b32 v43, v254
  v_lshlrev_b32 v34, 3, v0
  buffer_store_dwordx2 v[42:43], v34, s[56:59], s35 offen sc1
L_nobst:
  s_cmp_lg_u32 s32, 0
  s_cbranch_scc1 L_noctr
  v_mov_b32 v44, 0
  v_mov_b32 v45, v254
  s_mov_b64 exec, 1
  buffer_store_dwordx2 v[44:45], off, s[56:59], s35 offset:512 sc1
  s_mov_b64 exec, -1
L_noctr:
L_tickets:
  s_and_b32 s34, s2, 0xf8
  s_lshl_b32 s40, s34, 13
  s_add_u32 s40, s40, 2102784
  s_mov_b32 s36, 0
  s_mov_b32 s37, 0
  s_mov_b32 s38, 0
  s_mov_b32 s78, 0
  s_mov_b32 s80, 0
  v_mov_b32 v52, 0
  v_mov_b32 v53, 0
  s_mov_b32 s81, 0
  v_mov_b32 v54, 0
  v_mov_b32 v55, 0
  s_mov_b32 s82, 0
  v_mov_b32 v56, 0
  v_mov_b32 v57, 0
  s_mov_b32 s83, 0
  v_mov_b32 v58, 0
  v_mov_b32 v59, 0
  v_mov_b32 v45, 0
  s_waitcnt vmcnt(0)
L_tkwait:
  ds_read_b32 v35, v252 offset:0
  s_sleep 8
  s_waitcnt lgkmcnt(0)
  v_readfirstlane_b32 s34, v35
  s_cmp_lt_u32 s34, 475136
  s_cbranch_scc1 L_tkwait
  s_setprio 3
L_tkloop:
  s_waitcnt vmcnt(3)
  ds_read_b32 v35, v252
  v_readfirstlane_b32 s34, v52
  v_readfirstlane_b32 s35, v53
  s_sub_u32 s37, s37, s80
  s_cmp_eq_u32 s35, s76
  s_cselect_b32 s80, s80, 0
  s_cmp_eq_u32 s80, 0
  s_cbranch_scc1 L_tkn0
  s_add_u32 s35, s34, s80
  s_min_u32 s35, s35, 128
  s_min_u32 s41, s34, 128
  s_sub_u32 s41, s35, s41
  s_cmp_ge_u32 s35, 128
  s_cselect_b32 s38, 1, s38
  s_cmp_eq_u32 s41, 0
  s_cbranch_scc1 L_tkn0
  v_add_u32 v42, s34, v0
  v_lshrrev_b32 v43, 3, v42
  v_add_u32 v43, 240, v43
  v_and_b32 v46, 1, v43
  v_lshrrev_b32 v43, 1, v43
  v_lshlrev_b32 v43, 12, v43
  v_and_b32 v44, 4294934528, v43
  v_add3_u32 v43, v43, v44, 2
  v_lshl_add_u32 v43, v46, 15, v43
  v_and_b32 v42, 7, v42
  v_lshl_add_u32 v43, v42, 20, v43
  v_xor_b32 v43, s33, v43
  v_add_u32 v44, s36, v0
  v_lshlrev_b32 v44, 2, v44
  s_bfm_b64 exec, s41, 0
  ds_write_b32 v44, v43 offset:12288
  s_mov_b64 exec, -1
  s_add_u32 s36, s36, s41
L_tkn0:
  s_cmp_eq_u32 s38, 1
  s_cselect_b32 s35, s37, 1
  s_cmp_eq_u32 s35, 0
  s_cbranch_scc1 L_tkend
  s_waitcnt lgkmcnt(0)
  v_readfirstlane_b32 s34, v35
  s_lshr_b32 s34, s34, 11
  s_sub_u32 s34, s34, 234
  s_sub_u32 s34, s34, s36
  s_sub_u32 s34, s34, s37
  s_max_i32 s34, s34, 0
  s_min_i32 s34, s34, 3
  s_cmp_eq_u32 s38, 1
  s_cselect_b32 s80, 0, s34
  s_add_u32 s37, s37, s80
  v_mov_b32 v52, s80
  v_mov_b32 v53, 0
  s_cmp_eq_u32 s80, 0
  s_cselect_b32 s35, 1073741824, s40
  s_mov_b64 exec, 1
  buffer_atomic_add_x2 v[52:53], off, s[56:59], s35 sc0
  s_mov_b64 exec, -1
  s_waitcnt vmcnt(3)
  ds_read_b32 v35, v252
  v_readfirstlane_b32 s34, v54
  v_readfirstlane_b32 s35, v55
  s_sub_u32 s37, s37, s81
  s_cmp_eq_u32 s35, s76
  s_cselect_b32 s81, s81, 0
  s_cmp_eq_u32 s81, 0
  s_cbranch_scc1 L_tkn1
  s_add_u32 s35, s34, s81
  s_min_u32 s35, s35, 128
  s_min_u32 s41, s34, 128
  s_sub_u32 s41, s35, s41
  s_cmp_ge_u32 s35, 128
  s_cselect_b32 s38, 1, s38
  s_cmp_eq_u32 s41, 0
  s_cbranch_scc1 L_tkn1
  v_add_u32 v42, s34, v0
  v_lshrrev_b32 v43, 3, v42
  v_add_u32 v43, 240, v43
  v_and_b32 v46, 1, v43
  v_lshrrev_b32 v43, 1, v43
  v_lshlrev_b32 v43, 12, v43
  v_and_b32 v44, 4294934528, v43
  v_add3_u32 v43, v43, v44, 2
  v_lshl_add_u32 v43, v46, 15, v43
  v_and_b32 v42, 7, v42
  v_lshl_add_u32 v43, v42, 20, v43
  v_xor_b32 v43, s33, v43
  v_add_u32 v44, s36, v0
  v_lshlrev_b32 v44, 2, v44
  s_bfm_b64 exec, s41, 0
  ds_write_b32 v44, v43 offset:12288
  s_mov_b64 exec, -1
  s_add_u32 s36, s36, s41
L_tkn1:
  s_cmp_eq_u32 s38, 1
  s_cselect_b32 s35, s37, 1
  s_cmp_eq_u32 s35, 0
  s_cbranch_scc1 L_tkend
  s_waitcnt lgkmcnt(0)
  v_readfirstlane_b32 s34, v35
  s_lshr_b32 s34, s34, 11
  s_sub_u32 s34, s34, 234
  s_sub_u32 s34, s34, s36
  s_sub_u32 s34, s34, s37
  s_max_i32 s34, s34, 0
  s_min_i32 s34, s34, 3
  s_cmp_eq_u32 s38, 1
  s_cselect_b32 s81, 0, s34
  s_add_u32 s37, s37, s81
  v_mov_b32 v54, s81
  v_mov_b32 v55, 0
  s_cmp_eq_u32 s81, 0
  s_cselect_b32 s35, 1073741824, s40
  s_mov_b64 exec, 1
  buffer_atomic_add_x2 v[54:55], off, s[56:59], s35 sc0
  s_mov_b64 exec, -1
  s_waitcnt vmcnt(3)
  ds_read_b32 v35, v252
  v_readfirstlane_b32 s34, v56
  v_readfirstlane_b32 s35, v57
  s_sub_u32 s37, s37, s82
  s_cmp_eq_u32 s35, s76
  s_cselect_b32 s82, s82, 0
  s_cmp_eq_u32 s82, 0
  s_cbranch_scc1 L_tkn2
  s_add_u32 s35, s34, s82
  s_min_u32 s35, s35, 128
  s_min_u32 s41, s34, 128
  s_sub_u32 s41, s35, s41
  s_cmp_ge_u32 s35, 128
  s_cselect_b32 s38, 1, s38
  s_cmp_eq_u32 s41, 0
  s_cbranch_scc1 L_tkn2
  v_add_u32 v42, s34, v0
  v_lshrrev_b32 v43, 3, v42
  v_add_u32 v43, 240, v43
  v_and_b32 v46, 1, v43
  v_lshrrev_b32 v43, 1, v43
  v_lshlrev_b32 v43, 12, v43
  v_and_b32 v44, 4294934528, v43
  v_add3_u32 v43, v43, v44, 2
  v_lshl_add_u32 v43, v46, 15, v43
  v_and_b32 v42, 7, v42
  v_lshl_add_u32 v43, v42, 20, v43
  v_xor_b32 v43, s33, v43
  v_add_u32 v44, s36, v0
  v_lshlrev_b32 v44, 2, v44
  s_bfm_b64 exec, s41, 0
  ds_write_b32 v44, v43 offset:12288
  s_mov_b64 exec, -1
  s_add_u32 s36, s36, s41
L_tkn2:
  s_cmp_eq_u32 s38, 1
  s_cselect_b32 s35, s37, 1
  s_cmp_eq_u32 s35, 0
  s_cbranch_scc1 L_tkend
  s_waitcnt lgkmcnt(0)
  v_readfirstlane_b32 s34, v35
  s_lshr_b32 s34, s34, 11
  s_sub_u32 s34, s34, 234
  s_sub_u32 s34, s34, s36
  s_sub_u32 s34, s34, s37
  s_max_i32 s34, s34, 0
  s_min_i32 s34, s34, 3
  s_cmp_eq_u32 s38, 1
  s_cselect_b32 s82, 0, s34
  s_add_u32 s37, s37, s82
  v_mov_b32 v56, s82
  v_mov_b32 v57, 0
  s_cmp_eq_u32 s82, 0
  s_cselect_b32 s35, 1073741824, s40
  s_mov_b64 exec, 1
  buffer_atomic_add_x2 v[56:57], off, s[56:59], s35 sc0
  s_mov_b64 exec, -1
  s_waitcnt vmcnt(3)
  ds_read_b32 v35, v252
  v_readfirstlane_b32 s34, v58
  v_readfirstlane_b32 s35, v59
  s_sub_u32 s37, s37, s83
  s_cmp_eq_u32 s35, s76
  s_cselect_b32 s83, s83, 0
  s_cmp_eq_u32 s83, 0
  s_cbranch_scc1 L_tkn3
  s_add_u32 s35, s34, s83
  s_min_u32 s35, s35, 128
  s_min_u32 s41, s34, 128
  s_sub_u32 s41, s35, s41
  s_cmp_ge_u32 s35, 128
  s_cselect_b32 s38, 1, s38
  s_cmp_eq_u32 s41, 0
  s_cbranch_scc1 L_tkn3
  v_add_u32 v42, s34, v0
  v_lshrrev_b32 v43, 3, v42
  v_add_u32 v43, 240, v43
  v_and_b32 v46, 1, v43
  v_lshrrev_b32 v43, 1, v43
  v_lshlrev_b32 v43, 12, v43
  v_and_b32 v44, 4294934528, v43
  v_add3_u32 v43, v43, v44, 2
  v_lshl_add_u32 v43, v46, 15, v43
  v_and_b32 v42, 7, v42
  v_lshl_add_u32 v43, v42, 20, v43
  v_xor_b32 v43, s33, v43
  v_add_u32 v44, s36, v0
  v_lshlrev_b32 v44, 2, v44
  s_bfm_b64 exec, s41, 0
  ds_write_b32 v44, v43 offset:12288
  s_mov_b64 exec, -1
  s_add_u32 s36, s36, s41
L_tkn3:
  s_cmp_eq_u32 s38, 1
  s_cselect_b32 s35, s37, 1
  s_cmp_eq_u32 s35, 0
  s_cbranch_scc1 L_tkend
  s_waitcnt lgkmcnt(0)
  v_readfirstlane_b32 s34, v35
  s_lshr_b32 s34, s34, 11
  s_sub_u32 s34, s34, 234
  s_sub_u32 s34, s34, s36
  s_sub_u32 s34, s34, s37
  s_max_i32 s34, s34, 0
  s_min_i32 s34, s34, 3
  s_cmp_eq_u32 s38, 1
  s_cselect_b32 s83, 0, s34
  s_add_u32 s37, s37, s83
  v_mov_b32 v58, s83
  v_mov_b32 v59, 0
  s_cmp_eq_u32 s83, 0
  s_cselect_b32 s35, 1073741824, s40
  s_mov_b64 exec, 1
  buffer_atomic_add_x2 v[58:59], off, s[56:59], s35 sc0
  s_mov_b64 exec, -1
  s_add_u32 s78, s78, 1
  s_cmp_lt_u32 s78, 0x40000
  s_cbranch_scc1 L_tkloop
L_tkend:
  s_add_u32 s34, s36, 243
  s_lshl_b32 s34, s34, 11
  v_mov_b32 v45, s34
  ds_write_b32 v252, v45 offset:4
  v_add_u32 v44, s36, v0
  v_lshlrev_b32 v44, 2, v44
  v_mov_b32 v43, 1073741824
  ds_write_b32 v44, v43 offset:12288
  s_branch L_fin
.p2align 6
L_done:
  s_cmp_gt_u32 s3, 2
  s_cbranch_scc1 L_bufdone
  v_mov_b32 v40, v15
  s_nop 1
  v_permlane32_swap_b32 v40, v15
  v_add_f32 v15, v15, v40
  v_mov_b32 v40, v15
  s_nop 1
  v_permlane16_swap_b32 v40, v15
  v_add_f32 v15, v15, v40
  v_max_f32 v15, 0x0da24260, v15
  v_log_f32 v28, v15
  v_rcp_f32 v30, v15
  v_mov_b32 v29, v254
  v_sub_f32 v28, v28, v14
  v_mov_b32 v34, 1
  v_mov_b32_dpp v31, v30 row_ror:8 row_mask:0xf bank_mask:0xf
  v_mov_b32_dpp v32, v28 row_ror:8 row_mask:0xf bank_mask:0xf
  v_cndmask_b32 v30, v31, v30, s[74:75]
  v_cndmask_b32 v28, v32, v28, s[74:75]
  v_mul_f32 v16, v16, v30
  v_mul_f32 v17, v17, v30
  v_mul_f32 v18, v18, v30
  v_mul_f32 v19, v19, v30
  v_cvt_pk_bf16_f32 v26, v16, v17
  v_cvt_pk_bf16_f32 v27, v18, v19
  buffer_store_dwordx4 v[26:29], v249, s[56:59], s83 offen sc1
  s_mov_b64 exec, 1
  ds_add_u32 v252, v34 offset:20
  s_branch L_fin
L_bufdone:
  s_cmp_lg_u32 s86, 1
  s_cbranch_scc1 L_xr0
  s_mov_b32 s86, 2
  s_waitcnt vmcnt(0)
  v_mov_b64 v[64:65], v[128:129]
  v_mov_b64 v[66:67], v[130:131]
  v_mov_b64 v[68:69], v[132:133]
  v_mov_b64 v[70:71], v[134:135]
  v_mov_b64 v[72:73], v[136:137]
  v_mov_b64 v[74:75], v[138:139]
  v_mov_b64 v[76:77], v[140:141]
  v_mov_b64 v[78:79], v[142:143]
  v_mov_b64 v[80:81], v[144:145]
  v_mov_b64 v[82:83], v[146:147]
  v_mov_b64 v[84:85], v[148:149]
  v_mov_b64 v[86:87], v[150:151]
  v_mov_b64 v[88:89], v[152:153]
  v_mov_b64 v[90:91], v[154:155]
  v_mov_b64 v[92:93], v[156:157]
  v_mov_b64 v[94:95], v[158:159]
  s_mov_b32 s64, s66
  v_mov_b64 v[96:97], v[160:161]
  v_mov_b64 v[98:99], v[162:163]
  v_mov_b64 v[100:101], v[164:165]
  v_mov_b64 v[102:103], v[166:167]
  v_mov_b64 v[104:105], v[168:169]
  v_mov_b64 v[106:107], v[170:171]
  v_mov_b64 v[108:109], v[172:173]
  v_mov_b64 v[110:111], v[174:175]
  v_mov_b64 v[112:113], v[176:177]
  v_mov_b64 v[114:115], v[178:179]
  v_mov_b64 v[116:117], v[180:181]
  v_mov_b64 v[118:119], v[182:183]
  v_mov_b64 v[120:121], v[184:185]
  v_mov_b64 v[122:123], v[186:187]
  v_mov_b64 v[124:125], v[188:189]
  v_mov_b64 v[126:127], v[190:191]
  s_mov_b32 s65, s67
  s_branch L_loop
L_xr0:
  s_cmp_lg_u32 s86, 2
  s_cbranch_scc1 L_xr1
  s_mov_b32 s86, 3
  s_waitcnt vmcnt(0)
  v_mov_b64 v[64:65], v[192:193]
  v_mov_b64 v[66:67], v[194:195]
  v_mov_b64 v[68:69], v[196:197]
  v_mov_b64 v[70:71], v[198:199]
  v_mov_b64 v[72:73], v[200:201]
  v_mov_b64 v[74:75], v[202:203]
  v_mov_b64 v[76:77], v[204:205]
  v_mov_b64 v[78:79], v[206:207]
  v_mov_b64 v[80:81], v[208:209]
  v_mov_b64 v[82:83], v[210:211]
  v_mov_b64 v[84:85], v[212:213]
  v_mov_b64 v[86:87], v[214:215]
  v_mov_b64 v[88:89], v[216:217]
  v_mov_b64 v[90:91], v[218:219]
  v_mov_b64 v[92:93], v[220:221]
  v_mov_b64 v[94:95], v[222:223]
  s_mov_b32 s64, s68
  s_branch L_loop
L_xr1:
  s_waitcnt vmcnt(0)
  s_cmp_eq_u32 s3, 4
  s_cbranch_scc1 L_red
  s_cmp_lg_u32 s3, 3
  s_cbranch_scc1 L_fin
  s_lshl_b32 s66, s31, 2
  s_lshr_b32 s34, s32, 1
  s_or_b32 s66, s66, s34
  v_and_b32 v24, 7, v0
  v_bfe_u32 v25, v0, 3, 1
  v_lshl_add_u32 v24, v25, 7, v24
  v_lshlrev_b32 v24, 13, v24
  v_lshrrev_b32 v26, 4, v0
  v_lshl_add_u32 v24, v26, 4, v24
  s_lshl_b32 s64, s30, 16
  s_lshl_b32 s34, s66, 7
  s_add_u32 s64, s64, s34
  s_add_u32 s64, s64, 2097152
  s_lshl_b32 s34, s30, 3
  s_add_u32 s34, s34, s66
  s_mul_i32 s68, s34, 36864
  s_and_b32 s34, s32, 1
  s_mul_i32 s34, s34, 576
  s_add_u32 s68, s68, s34
  s_mov_b32 s69, 14336
  v_mul_u32_u24 v26, 4608, v26
  v_bfe_u32 v27, v0, 2, 2
  v_mul_u32_u24 v27, 576, v27
  v_and_b32 v28, 3, v0
  v_lshlrev_b32 v28, 3, v28
  v_add3_u32 v26, v26, v27, v28
  v_and_b32 v27, 15, v0
  v_lshlrev_b32 v27, 4, v27
  v_lshrrev_b32 v28, 5, v0
  v_lshl_add_u32 v27, v28, 8, v27
  v_bfe_u32 v28, v0, 4, 1
  v_lshl_add_u32 v27, v28, 9, v27
  v_mov_b32 v7, v254
  v_mov_b32 v11, v254
  v_mov_b32 v15, v254
  s_mov_b32 s86, 0xffff0000
  s_mov_b32 s87, 0xffff0000
  s_lshl_b32 s81, s2, 13
  s_add_u32 s81, s81, 2099200
L_w3a:
  ds_read_b32 v35, v252 offset:0
  s_sleep 32
  s_waitcnt lgkmcnt(0)
  v_readfirstlane_b32 s34, v35
  s_cmp_lt_u32 s34, 479232
  s_cbranch_scc1 L_w3a
L_fwait:
  ds_read_b64 v[36:37], v252
  s_sleep 2
  s_waitcnt lgkmcnt(0)
  v_readfirstlane_b32 s34, v36
  v_readfirstlane_b32 s35, v37
  s_cmp_lt_u32 s34, s35
  s_cbranch_scc1 L_fwait
  s_mov_b32 exec_hi, 0xf
L_dmaloop:
  s_mov_b32 m0, s69
  s_add_u32 s69, s69, 576
  buffer_load_dwordx4 v253, s[52:55], s68 offen nt lds
  s_add_u32 s68, s68, 1152
  s_cmp_lt_u32 s69, 32768
  s_cbranch_scc1 L_dmaloop
  s_mov_b64 exec, -1
L_w3b:
  ds_read_b32 v35, v252 offset:20
  s_waitcnt lgkmcnt(0)
  v_readfirstlane_b32 s34, v35
  s_cmp_lt_u32 s34, 2
  s_cbranch_scc1 L_w3b
  s_mov_b32 s78, 0
  buffer_load_dwordx4 v[64:67], v24, s[56:59], s64 offen offset:0 sc1
  buffer_load_dwordx4 v[68:71], v24, s[56:59], s64 offen offset:64 sc1
  buffer_load_dwordx4 v[72:75], v24, s[56:59], s64 offen offset:1024 sc1
  buffer_load_dwordx4 v[76:79], v24, s[56:59], s64 offen offset:1088 sc1
  s_waitcnt vmcnt(4)
  ds_read_b64_tr_b16 v[128:129], v26 offset:14336
  ds_read_b64_tr_b16 v[130:131], v26 offset:16640
  ds_read_b64_tr_b16 v[132:133], v26 offset:14368
  ds_read_b64_tr_b16 v[134:135], v26 offset:16672
  ds_read_b64_tr_b16 v[136:137], v26 offset:14400
  ds_read_b64_tr_b16 v[138:139], v26 offset:16704
  ds_read_b64_tr_b16 v[140:141], v26 offset:14432
  ds_read_b64_tr_b16 v[142:143], v26 offset:16736
  ds_read_b64_tr_b16 v[144:145], v26 offset:14464
  ds_read_b64_tr_b16 v[146:147], v26 offset:16768
  ds_read_b64_tr_b16 v[148:149], v26 offset:14496
  ds_read_b64_tr_b16 v[150:151], v26 offset:16800
  ds_read_b64_tr_b16 v[152:153], v26 offset:14528
  ds_read_b64_tr_b16 v[154:155], v26 offset:16832
  ds_read_b64_tr_b16 v[156:157], v26 offset:14560
  ds_read_b64_tr_b16 v[158:159], v26 offset:16864
  ds_read_b64_tr_b16 v[160:161], v26 offset:14592
  ds_read_b64_tr_b16 v[162:163], v26 offset:16896
  ds_read_b64_tr_b16 v[164:165], v26 offset:14624
  ds_read_b64_tr_b16 v[166:167], v26 offset:16928
  ds_read_b64_tr_b16 v[168:169], v26 offset:14656
  ds_read_b64_tr_b16 v[170:171], v26 offset:16960
  ds_read_b64_tr_b16 v[172:173], v26 offset:14688
  ds_read_b64_tr_b16 v[174:175], v26 offset:16992
  ds_read_b64_tr_b16 v[176:177], v26 offset:14720
  ds_read_b64_tr_b16 v[178:179], v26 offset:17024
  ds_read_b64_tr_b16 v[180:181], v26 offset:14752
  ds_read_b64_tr_b16 v[182:183], v26 offset:17056
  ds_read_b64_tr_b16 v[184:185], v26 offset:14784
  ds_read_b64_tr_b16 v[186:187], v26 offset:17088
  ds_read_b64_tr_b16 v[188:189], v26 offset:14816
  ds_read_b64_tr_b16 v[190:191], v26 offset:17120
  ds_read_b64_tr_b16 v[192:193], v26 offset:14848
  ds_read_b64_tr_b16 v[194:195], v26 offset:17152
  ds_read_b64_tr_b16 v[196:197], v26 offset:14880
  ds_read_b64_tr_b16 v[198:199], v26 offset:17184
  s_branch L_poll1c
L_poll1:
  buffer_load_dwordx4 v[64:67], v24, s[56:59], s64 offen offset:0 sc1
  buffer_load_dwordx4 v[68:71], v24, s[56:59], s64 offen offset:64 sc1
  buffer_load_dwordx4 v[72:75], v24, s[56:59], s64 offen offset:1024 sc1
  buffer_load_dwordx4 v[76:79], v24, s[56:59], s64 offen offset:1088 sc1
L_poll1c:
  s_waitcnt vmcnt(0)
  v_max_u32 v35, v67, v71
  v_min_u32 v36, v67, v71
  v_max3_u32 v35, v35, v75, v79
  v_min3_u32 v36, v36, v75, v79
  v_xor_b32 v35, v35, v254
  v_xor_b32 v36, v36, v254
  v_or_b32 v35, v35, v36
  v_cmp_ne_u32 vcc, 0, v35
  s_cbranch_vccz L_poll1ok
  s_mov_b64 exec, vcc
  s_sleep 1
  s_add_u32 s78, s78, 1
  s_cmp_lt_u32 s78, 0x40000
  s_cbranch_scc1 L_poll1
L_poll1ok:
  s_mov_b64 exec, -1
  v_max_f32 v34, v66, v74
  v_lshlrev_b32 v80, 16, v64
  v_and_b32 v81, 0xffff0000, v64
  v_max_f32_dpp v34, v34, v34 quad_perm:[1,0,3,2] row_mask:0xf bank_mask:0xf
  v_lshlrev_b32 v82, 16, v65
  v_and_b32 v83, 0xffff0000, v65
  v_max_f32_dpp v34, v34, v34 quad_perm:[2,3,0,1] row_mask:0xf bank_mask:0xf
  v_lshlrev_b32 v84, 16, v68
  v_and_b32 v85, 0xffff0000, v68
  v_max_f32_dpp v34, v34, v34 row_half_mirror row_mask:0xf bank_mask:0xf
  v_sub_f32 v36, v66, v34
  v_sub_f32 v37, v74, v34
  v_exp_f32 v36, v36
  v_exp_f32 v37, v37
  v_lshlrev_b32 v86, 16, v69
  v_and_b32 v87, 0xffff0000, v69
  v_add_f32 v34, v36, v37
  v_lshlrev_b32 v88, 16, v72
  v_and_b32 v89, 0xffff0000, v72
  v_add_f32_dpp v34, v34, v34 quad_perm:[1,0,3,2] row_mask:0xf bank_mask:0xf
  v_lshlrev_b32 v90, 16, v73
  v_and_b32 v91, 0xffff0000, v73
  v_add_f32_dpp v34, v34, v34 quad_perm:[2,3,0,1] row_mask:0xf bank_mask:0xf
  v_lshlrev_b32 v92, 16, v76
  v_and_b32 v93, 0xffff0000, v76
  v_add_f32_dpp v34, v34, v34 row_half_mirror row_mask:0xf bank_mask:0xf
  v_lshlrev_b32 v94, 16, v77
  v_and_b32 v95, 0xffff0000, v77
  v_rcp_f32 v34, v34
  s_nop 0
  v_mul_f32 v36, v36, v34
  v_mul_f32 v38, v37, v34
  v_pk_mul_f32 v[104:105], v[80:81], v[36:37] op_sel_hi:[1,0]
  v_pk_mul_f32 v[106:107], v[82:83], v[36:37] op_sel_hi:[1,0]
  v_pk_mul_f32 v[108:109], v[84:85], v[36:37] op_sel_hi:[1,0]
  v_pk_mul_f32 v[110:111], v[86:87], v[36:37] op_sel_hi:[1,0]
  v_pk_fma_f32 v[104:105], v[88:89], v[38:39], v[104:105] op_sel_hi:[1,0,1]
  v_pk_fma_f32 v[106:107], v[90:91], v[38:39], v[106:107] op_sel_hi:[1,0,1]
  v_pk_fma_f32 v[108:109], v[92:93], v[38:39], v[108:109] op_sel_hi:[1,0,1]
  v_pk_fma_f32 v[110:111], v[94:95], v[38:39], v[110:111] op_sel_hi:[1,0,1]
  v_add_f32_dpp v104, v104, v104 quad_perm:[1,0,3,2] row_mask:0xf bank_mask:0xf
  v_add_f32_dpp v105, v105, v105 quad_perm:[1,0,3,2] row_mask:0xf bank_mask:0xf
  v_add_f32_dpp v106, v106, v106 quad_perm:[1,0,3,2] row_mask:0xf bank_mask:0xf
  v_add_f32_dpp v107, v107, v107 quad_perm:[1,0,3,2] row_mask:0xf bank_mask:0xf
  v_add_f32_dpp v108, v108, v108 quad_perm:[1,0,3,2] row_mask:0xf bank_mask:0xf
  v_add_f32_dpp v109, v109, v109 quad_perm:[1,0,3,2] row_mask:0xf bank_mask:0xf
  v_add_f32_dpp v110, v110, v110 quad_perm:[1,0,3,2] row_mask:0xf bank_mask:0xf
  v_add_f32_dpp v111, v111, v111 quad_perm:[1,0,3,2] row_mask:0xf bank_mask:0xf
  v_add_f32_dpp v104, v104, v104 quad_perm:[2,3,0,1] row_mask:0xf bank_mask:0xf
  v_add_f32_dpp v105, v105, v105 quad_perm:[2,3,0,1] row_mask:0xf bank_mask:0xf
  v_add_f32_dpp v106, v106, v106 quad_perm:[2,3,0,1] row_mask:0xf bank_mask:0xf
  v_add_f32_dpp v107, v107, v107 quad_perm:[2,3,0,1] row_mask:0xf bank_mask:0xf
  v_add_f32_dpp v108, v108, v108 quad_perm:[2,3,0,1] row_mask:0xf bank_mask:0xf
  v_add_f32_dpp v109, v109, v109 quad_perm:[2,3,0,1] row_mask:0xf bank_mask:0xf
  v_add_f32_dpp v110, v110, v110 quad_perm:[2,3,0,1] row_mask:0xf bank_mask:0xf
  v_add_f32_dpp v111, v111, v111 quad_perm:[2,3,0,1] row_mask:0xf bank_mask:0xf
  v_add_f32_dpp v104, v104, v104 row_half_mirror row_mask:0xf bank_mask:0xf
  v_add_f32_dpp v105, v105, v105 row_half_mirror row_mask:0xf bank_mask:0xf
  v_add_f32_dpp v106, v106, v106 row_half_mirror row_mask:0xf bank_mask:0xf
  v_add_f32_dpp v107, v107, v107 row_half_mirror row_mask:0xf bank_mask:0xf
  v_add_f32_dpp v108, v108, v108 row_half_mirror row_mask:0xf bank_mask:0xf
  v_add_f32_dpp v109, v109, v109 row_half_mirror row_mask:0xf bank_mask:0xf
  v_add_f32_dpp v110, v110, v110 row_half_mirror row_mask:0xf bank_mask:0xf
  v_add_f32_dpp v111, v111, v111 row_half_mirror row_mask:0xf bank_mask:0xf
  v_cvt_pk_bf16_f32 v40, v104, v105
  v_cvt_pk_bf16_f32 v41, v106, v107
  v_cvt_pk_bf16_f32 v42, v108, v109
  v_cvt_pk_bf16_f32 v43, v110, v111
  s_waitcnt lgkmcnt(0)
  s_nop 0
  v_mfma_f32_16x16x32_bf16 v[200:203], v[40:43], v[128:131], 0
  v_mfma_f32_16x16x32_bf16 v[204:207], v[40:43], v[132:135], 0
  v_mfma_f32_16x16x32_bf16 v[208:211], v[40:43], v[136:139], 0
  v_mfma_f32_16x16x32_bf16 v[212:215], v[40:43], v[140:143], 0
  v_mfma_f32_16x16x32_bf16 v[216:219], v[40:43], v[144:147], 0
  v_mfma_f32_16x16x32_bf16 v[220:223], v[40:43], v[148:151], 0
  v_mfma_f32_16x16x32_bf16 v[224:227], v[40:43], v[152:155], 0
  v_mfma_f32_16x16x32_bf16 v[228:231], v[40:43], v[156:159], 0
  v_mfma_f32_16x16x32_bf16 v[232:235], v[40:43], v[160:163], 0
  v_mfma_f32_16x16x32_bf16 v[236:239], v[40:43], v[164:167], 0
  v_mfma_f32_16x16x32_bf16 v[240:243], v[40:43], v[168:171], 0
  v_mfma_f32_16x16x32_bf16 v[244:247], v[40:43], v[172:175], 0
  v_mfma_f32_16x16x32_bf16 v[112:115], v[40:43], v[176:179], 0
  v_mfma_f32_16x16x32_bf16 v[116:119], v[40:43], v[180:183], 0
  v_cndmask_b32 v4, v200, v212, s[86:87]
  v_cndmask_b32 v5, v204, v216, s[86:87]
  v_cndmask_b32 v6, v208, v220, s[86:87]
  buffer_store_dwordx4 v[4:7], v27, s[56:59], s81 offen offset:0 sc1
  v_mfma_f32_16x16x32_bf16 v[120:123], v[40:43], v[184:187], 0
  v_mfma_f32_16x16x32_bf16 v[124:127], v[40:43], v[188:191], 0
  v_mfma_f32_16x16x32_bf16 v[48:51], v[40:43], v[192:195], 0
  v_mfma_f32_16x16x32_bf16 v[52:55], v[40:43], v[196:199], 0
  v_cndmask_b32 v8, v224, v236, s[86:87]
  v_cndmask_b32 v9, v228, v240, s[86:87]
  v_cndmask_b32 v10, v232, v244, s[86:87]
  buffer_store_dwordx4 v[8:11], v27, s[56:59], s81 offen offset:1024 sc1
  s_nop 1
  v_cndmask_b32 v12, v112, v124, s[86:87]
  v_cndmask_b32 v13, v116, v48, s[86:87]
  v_cndmask_b32 v14, v120, v52, s[86:87]
  buffer_store_dwordx4 v[12:15], v27, s[56:59], s81 offen offset:2048 sc1
  v_mov_b32 v34, 1
  s_mov_b64 exec, 1
  ds_write_b32 v252, v34 offset:24
  s_branch L_fin
L_red:
  s_mul_i32 s34, s2, 205
  s_lshr_b32 s34, s34, 10
  s_mul_i32 s35, s34, 5
  s_cmp_lg_u32 s35, s2
  s_cbranch_scc1 L_fin
  s_cmp_ge_u32 s34, 48
  s_cbranch_scc1 L_fin
  s_and_b32 s64, s34, 1
  s_bfe_u32 s65, s34, 0x10001
  s_bfe_u32 s66, s34, 0x10002
  s_lshr_b32 s67, s34, 3
  s_mov_b32 s44, s4
  s_and_b32 s45, s5, 0xffff
  s_mov_b32 s46, 2304
  s_mov_b32 s47, 0x20000
  s_mov_b32 s60, s24
  s_and_b32 s61, s25, 0xffff
  s_mov_b32 s62, 2304
  s_mov_b32 s63, 0x20000
  s_load_dword s79, s[22:23], 0
  s_mul_i32 s34, s66, 288
  s_mul_i32 s35, s67, 48
  s_add_u32 s34, s34, s35
  s_lshl_b32 s35, s64, 3
  s_add_u32 s34, s34, s35
  v_and_b32 v24, 7, v0
  v_lshrrev_b32 v25, 3, v0
  v_add_u32 v26, s34, v24
  s_mul_i32 s35, s65, 1152
  v_lshl_add_u32 v51, v26, 1, s35
  v_lshrrev_b32 v27, 6, v26
  v_mad_u32_u24 v27, v25, 9, v27
  v_lshlrev_b32 v27, 13, v27
  v_and_b32 v28, 63, v26
  v_lshl_add_u32 v52, v28, 3, v27
  v_add_u32 v26, 16, v26
  v_lshrrev_b32 v27, 6, v26
  v_mad_u32_u24 v27, v25, 9, v27
  v_lshlrev_b32 v27, 13, v27
  v_and_b32 v28, 63, v26
  v_lshl_add_u32 v53, v28, 3, v27
  v_add_u32 v26, 16, v26
  v_lshrrev_b32 v27, 6, v26
  v_mad_u32_u24 v27, v25, 9, v27
  v_lshlrev_b32 v27, 13, v27
  v_and_b32 v28, 63, v26
  v_lshl_add_u32 v54, v28, 3, v27
  s_lshl_b32 s68, s65, 20
  s_add_u32 s68, s68, 2102272
  s_add_u32 s69, s68, 589824
  v_lshlrev_b32 v28, 18, v25
  v_lshl_add_u32 v28, v24, 4, v28
  s_lshl_b32 s81, s66, 13
  s_lshl_b32 s34, s67, 9
  s_add_u32 s81, s81, s34
  s_lshl_b32 s34, s65, 8
  s_add_u32 s81, s81, s34
  s_lshl_b32 s34, s64, 7
  s_add_u32 s81, s81, s34
  s_add_u32 s81, s81, 2099200
L_w4a:
  ds_read_b32 v35, v252 offset:0
  s_sleep 32
  s_waitcnt lgkmcnt(0)
  v_readfirstlane_b32 s34, v35
  s_cmp_lt_u32 s34, 491520
  s_cbranch_scc1 L_w4a
L_w4b:
  ds_read_b32 v35, v252 offset:20
  s_sleep 4
  s_waitcnt lgkmcnt(0)
  v_readfirstlane_b32 s34, v35
  s_cmp_lt_u32 s34, 1
  s_cbranch_scc1 L_w4b
  v_bfe_u32 v29, v0, 4, 1
  v_lshlrev_b32 v29, 6, v29
  v_lshrrev_b32 v30, 4, v0
  v_cmp_eq_u32 vcc, 2, v30
  v_add_u32 v51, v51, v29
  v_add_u32 v30, 32, v51
  v_cndmask_b32 v51, v51, v30, vcc
  buffer_load_ushort v44, v51, s[44:47], 0 offen
  s_mov_b32 s78, 0
  v_mov_b32 v70, 0
  v_mov_b32 v71, v254
  v_mov_b32 v72, 0
  v_mov_b32 v73, v254
  v_mov_b32 v74, 0
  v_mov_b32 v75, v254
L_pollb:
  buffer_load_dwordx2 v[64:65], v52, s[56:59], s68 offen sc1
  buffer_load_dwordx2 v[66:67], v53, s[56:59], s68 offen sc1
  buffer_load_dwordx2 v[68:69], v54, s[56:59], s68 offen sc1
  s_mov_b32 exec_hi, 0
  buffer_load_dwordx2 v[70:71], v52, s[56:59], s69 offen sc1
  buffer_load_dwordx2 v[72:73], v53, s[56:59], s69 offen sc1
  buffer_load_dwordx2 v[74:75], v54, s[56:59], s69 offen sc1
  s_mov_b32 exec_hi, -1
  s_waitcnt vmcnt(0)
  v_max_u32 v35, v65, v67
  v_min_u32 v36, v65, v67
  v_max3_u32 v35, v35, v69, v71
  v_min3_u32 v36, v36, v69, v71
  v_max3_u32 v35, v35, v73, v75
  v_min3_u32 v36, v36, v73, v75
  v_xor_b32 v35, v35, v254
  v_xor_b32 v36, v36, v254
  v_or_b32 v35, v35, v36
  v_cmp_ne_u32 vcc, 0, v35
  s_cbranch_vccz L_gotb
  s_sleep 8
  s_add_u32 s78, s78, 1
  s_cmp_lt_u32 s78, 0x40000
  s_cbranch_scc1 L_pollb
L_gotb:
  v_add_f32 v48, v64, v70
  v_add_f32 v49, v66, v72
  v_add_f32 v50, v68, v74
  v_mov_b32 v34, v50
  s_nop 0
  v_permlane32_swap_b32 v48, v49
  v_permlane32_swap_b32 v50, v34
  v_add_f32 v48, v48, v49
  v_add_f32 v50, v50, v34
  s_nop 1
  v_permlane16_swap_b32 v48, v50
  v_add_f32 v48, v48, v50
  s_nop 1
  v_add_f32_dpp v48, v48, v48 row_ror:8 row_mask:0xf bank_mask:0xf
  s_lshl_b32 s79, s79, 16
  v_cvt_pk_bf16_f32 v48, v48, v48
  v_and_b32 v48, 0xffff0000, v48
  v_add_f32 v48, s79, v48
  v_cvt_pk_bf16_f32 v48, v48, v48
  v_and_b32 v48, 0xffff0000, v48
  v_lshlrev_b32 v44, 16, v44
L_w4c:
  ds_read_b32 v35, v252 offset:24
  s_waitcnt lgkmcnt(0)
  v_readfirstlane_b32 s34, v35
  s_cmp_lt_u32 s34, 1
  s_cbranch_scc1 L_w4c
  s_mov_b32 s78, 0
L_poll2:
  s_mov_b32 s35, s81
  buffer_load_dwordx4 v[64:67], v28, s[56:59], s35 offen sc1
  s_add_u32 s35, s35, 16384
  buffer_load_dwordx4 v[68:71], v28, s[56:59], s35 offen sc1
  s_add_u32 s35, s35, 16384
  buffer_load_dwordx4 v[72:75], v28, s[56:59], s35 offen sc1
  s_add_u32 s35, s35, 16384
  buffer_load_dwordx4 v[76:79], v28, s[56:59], s35 offen sc1
  s_add_u32 s35, s35, 16384
  buffer_load_dwordx4 v[80:83], v28, s[56:59], s35 offen sc1
  s_add_u32 s35, s35, 16384
  buffer_load_dwordx4 v[84:87], v28, s[56:59], s35 offen sc1
  s_add_u32 s35, s35, 16384
  buffer_load_dwordx4 v[88:91], v28, s[56:59], s35 offen sc1
  s_add_u32 s35, s35, 16384
  buffer_load_dwordx4 v[92:95], v28, s[56:59], s35 offen sc1
  s_add_u32 s35, s35, 16384
  buffer_load_dwordx4 v[96:99], v28, s[56:59], s35 offen sc1
  s_add_u32 s35, s35, 16384
  buffer_load_dwordx4 v[100:103], v28, s[56:59], s35 offen sc1
  s_add_u32 s35, s35, 16384
  buffer_load_dwordx4 v[104:107], v28, s[56:59], s35 offen sc1
  s_add_u32 s35, s35, 16384
  buffer_load_dwordx4 v[108:111], v28, s[56:59], s35 offen sc1
  s_add_u32 s35, s35, 16384
  buffer_load_dwordx4 v[112:115], v28, s[56:59], s35 offen sc1
  s_add_u32 s35, s35, 16384
  buffer_load_dwordx4 v[116:119], v28, s[56:59], s35 offen sc1
  s_add_u32 s35, s35, 16384
  buffer_load_dwordx4 v[120:123], v28, s[56:59], s35 offen sc1
  s_add_u32 s35, s35, 16384
  buffer_load_dwordx4 v[124:127], v28, s[56:59], s35 offen sc1
  s_mov_b64 exec, -1
  s_waitcnt vmcnt(14)
  v_pk_add_f32 v[40:41], v[64:65], v[68:69]
  v_add_f32 v42, v66, v70
  v_max_u32 v35, v67, v71
  v_min_u32 v36, v67, v71
  s_waitcnt vmcnt(13)
  v_pk_add_f32 v[40:41], v[40:41], v[72:73]
  v_add_f32 v42, v42, v74
  s_waitcnt vmcnt(12)
  v_pk_add_f32 v[40:41], v[40:41], v[76:77]
  v_add_f32 v42, v42, v78
  v_max3_u32 v35, v35, v75, v79
  v_min3_u32 v36, v36, v75, v79
  s_waitcnt vmcnt(11)
  v_pk_add_f32 v[40:41], v[40:41], v[80:81]
  v_add_f32 v42, v42, v82
  s_waitcnt vmcnt(10)
  v_pk_add_f32 v[40:41], v[40:41], v[84:85]
  v_add_f32 v42, v42, v86
  v_max3_u32 v35, v35, v83, v87
  v_min3_u32 v36, v36, v83, v87
  s_waitcnt vmcnt(9)
  v_pk_add_f32 v[40:41], v[40:41], v[88:89]
  v_add_f32 v42, v42, v90
  s_waitcnt vmcnt(8)
  v_pk_add_f32 v[40:41], v[40:41], v[92:93]
  v_add_f32 v42, v42, v94
  v_max3_u32 v35, v35, v91, v95
  v_min3_u32 v36, v36, v91, v95
  s_waitcnt vmcnt(7)
  v_pk_add_f32 v[40:41], v[40:41], v[96:97]
  v_add_f32 v42, v42, v98
  s_waitcnt vmcnt(6)
  v_pk_add_f32 v[40:41], v[40:41], v[100:101]
  v_add_f32 v42, v42, v102
  v_max3_u32 v35, v35, v99, v103
  v_min3_u32 v36, v36, v99, v103
  s_waitcnt vmcnt(5)
  v_pk_add_f32 v[40:41], v[40:41], v[104:105]
  v_add_f32 v42, v42, v106
  s_waitcnt vmcnt(4)
  v_pk_add_f32 v[40:41], v[40:41], v[108:109]
  v_add_f32 v42, v42, v110
  v_max3_u32 v35, v35, v107, v111
  v_min3_u32 v36, v36, v107, v111
  s_waitcnt vmcnt(3)
  v_pk_add_f32 v[40:41], v[40:41], v[112:113]
  v_add_f32 v42, v42, v114
  s_waitcnt vmcnt(2)
  v_pk_add_f32 v[40:41], v[40:41], v[116:117]
  v_add_f32 v42, v42, v118
  v_max3_u32 v35, v35, v115, v119
  v_min3_u32 v36, v36, v115, v119
  s_waitcnt vmcnt(1)
  v_pk_add_f32 v[40:41], v[40:41], v[120:121]
  v_add_f32 v42, v42, v122
  s_waitcnt vmcnt(0)
  v_pk_add_f32 v[40:41], v[40:41], v[124:125]
  v_add_f32 v42, v42, v126
  v_max3_u32 v35, v35, v123, v127
  v_min3_u32 v36, v36, v123, v127
  v_cmp_ne_u32 vcc, v35, v254
  v_cmp_ne_u32 s[82:83], v36, v254
  s_or_b64 vcc, vcc, s[82:83]
  s_cbranch_scc0 L_got2
  s_mov_b64 exec, vcc
  s_sleep 1
  s_add_u32 s78, s78, 1
  s_cmp_lt_u32 s78, 0x40000
  s_cbranch_scc1 L_poll2
  s_mov_b64 exec, -1
L_got2:
  v_mov_b32 v34, v42
  s_nop 0
  v_permlane32_swap_b32 v40, v41
  v_permlane32_swap_b32 v42, v34
  v_add_f32 v40, v40, v41
  v_add_f32 v42, v42, v34
  s_nop 1
  v_permlane16_swap_b32 v40, v42
  v_add_f32 v40, v40, v42
  s_nop 1
  v_add_f32_dpp v40, v40, v40 row_ror:8 row_mask:0xf bank_mask:0xf
  v_cvt_pk_bf16_f32 v40, v40, v40
  v_and_b32 v40, 0xffff0000, v40
  v_add_f32 v40, v40, v44
  v_cvt_pk_bf16_f32 v40, v40, v40
  v_and_b32 v40, 0xffff0000, v40
  v_add_f32 v40, v40, v48
  v_cvt_pk_bf16_f32 v40, v40, v40
  s_mov_b32 exec_lo, 0x00ff00ff
  s_mov_b32 exec_hi, 0x000000ff
  buffer_store_short v40, v51, s[60:63], 0 offen
  s_cmp_lg_u32 s2, 0
  s_cbranch_scc1 L_fin
  s_mov_b64 exec, 1
  s_mov_b32 s34, 4194304
  buffer_store_dword v254, off, s[56:59], 0
  buffer_store_dword v254, off, s[56:59], s34
L_fin:
L_end:
  s_endpgm
.section .rodata,"a"
.p2align 6
.amdhsa_kernel parallel_sum__gqa_block_cached__mixer_token_mlp__decode_kernel
  .amdhsa_next_free_vgpr 256
  .amdhsa_next_free_sgpr 102
  .amdhsa_accum_offset 256
  .amdhsa_group_segment_fixed_size 0
  .amdhsa_kernarg_size 104
  .amdhsa_user_sgpr_count 2
  .amdhsa_user_sgpr_kernarg_segment_ptr 1
  .amdhsa_system_sgpr_workgroup_id_x 1
  .amdhsa_float_denorm_mode_32 3
.end_amdhsa_kernel
```
